```python
import torch

def _softmax(x, axis=-1):
    return torch.softmax(x, dim=axis)
def _gelu(x):
    return torch.nn.functional.gelu(x, approximate="tanh")
def _silu(x):
    return torch.nn.functional.silu(x)
def _sigmoid(x):
    return torch.sigmoid(x)
def _layernorm(x, axis=-1, eps=1e-5):
    m = x.mean(dim=axis, keepdim=True)
    v = x.var(dim=axis, keepdim=True, unbiased=False)
    return (x - m) / torch.sqrt(v + eps)
def _scatter_add(tgt, idx, src, axis=0):
    return tgt.clone().index_add_(axis, idx, src)
def _segment_sum(src, seg, n):
    out = torch.zeros((n,) + src.shape[1:], dtype=src.dtype)
    return out.index_add_(0, seg, src)
def _pad(x, pw):
    flat = tuple(v for pair in reversed(pw) for v in pair)
    return torch.nn.functional.pad(x, flat)

kernel_name = 'parallel_sum__grouped_kv_mqa__glu_gated_geglu__prompt'

def setup_inputs():

    _w = (lambda a: (lambda t: t.to(torch.bfloat16) if t.is_floating_point() else t)(torch.as_tensor(a)))
    def _A_setup():
        B, S, D, H = 1, 2048, 512, 32
        Dh = D // H
        return {
            "x": _w((lambda *s: torch.randn(*s, dtype=torch.bfloat16) * 0.05)(B, S, D)),
            "wq": _w((lambda *s: torch.randn(*s, dtype=torch.bfloat16) * 0.05)(D, H * Dh)),
            "wk": _w((lambda *s: torch.randn(*s, dtype=torch.bfloat16) * 0.05)(D, Dh)),
            "wv": _w((lambda *s: torch.randn(*s, dtype=torch.bfloat16) * 0.05)(D, Dh)),
            "wo": _w((lambda *s: torch.randn(*s, dtype=torch.bfloat16) * 0.05)(H * Dh, D)),
        }
    _A_in = _A_setup()

    def _B_setup():
        B, S, Dm, Df = 1, 2048, 512, 1376
        return {
            "x": _w((lambda *s: torch.randn(*s, dtype=torch.bfloat16) * 0.05)(B, S, Dm)),
            "w_gate": _w((lambda *s: torch.randn(*s, dtype=torch.bfloat16) * 0.4)(Dm, Df) * (Dm ** -0.5)),
            "w_up": _w((lambda *s: torch.randn(*s, dtype=torch.bfloat16) * 0.4)(Dm, Df) * (Dm ** -0.5)),
            "w_down": _w((lambda *s: torch.randn(*s, dtype=torch.bfloat16) * 0.4)(Df, Dm) * (Df ** -0.5)),
        }
    _B_in = _B_setup()

    return {
        "A_x": _A_in["x"],
        "A_wq": _A_in["wq"],
        "A_wk": _A_in["wk"],
        "A_wv": _A_in["wv"],
        "A_wo": _A_in["wo"],
        "B_x": _B_in["x"],
        "B_w_gate": _B_in["w_gate"],
        "B_w_up": _B_in["w_up"],
        "B_w_down": _B_in["w_down"],
    }

def reference(A_x, A_wq, A_wk, A_wv, A_wo, B_x, B_w_gate, B_w_up, B_w_down):
    def _A_ref(x, wq, wk, wv, wo):
        B, S, D = x.shape
        H = 32
        Dh = D // H
        q = (lambda x, *d: x.permute(*d))((x @ wq).reshape(B, S, H, Dh), 0, 2, 1, 3)
        k = x @ wk
        v = x @ wv
        scores = torch.einsum("bhqd,bkd->bhqk", q, k) * (Dh ** -0.5)
        p = _softmax(scores, axis=-1)
        o = torch.einsum("bhqk,bkd->bhqd", p, v)
        return (lambda x, *d: x.permute(*d))(o, 0, 2, 1, 3).reshape(B, S, H * Dh) @ wo

    def _B_ref(x, w_gate, w_up, w_down):
        g = torch.einsum("bsd,df->bsf", x, w_gate)
        u = torch.einsum("bsd,df->bsf", x, w_up)
        h = _gelu(g) * u
        return torch.einsum("bsf,fd->bsd", h, w_down)

    x = A_x
    xn = _layernorm(x, axis=-1)
    return x + _A_ref(xn, A_wq, A_wk, A_wv, A_wo) + _B_ref(xn, B_w_gate, B_w_up, B_w_down)
```

```asm
; @launch kernel=prep_kernel grid=(256,1,1) block=(1024,1,1) lds=163840
; @launch kernel=attn_kernel grid=(256,1,1) block=(768,1,1) lds=163840
; @launch kernel=outp_kernel grid=(256,1,1) block=(256,1,1) lds=65536
.amdgcn_target "amdgcn-amd-amdhsa--gfx950"
.text
.globl prep_kernel
.p2align 8
.type prep_kernel,@function
prep_kernel:
    s_cmp_ge_u32 s2, 256
    s_cbranch_scc1 k1_end
    s_load_dwordx8 s[4:11], s[0:1], 0
    s_load_dwordx2 s[12:13], s[0:1], 32
    s_load_dwordx4 s[16:19], s[0:1], 48
    s_load_dwordx2 s[20:21], s[0:1], 64
    s_load_dwordx2 s[22:23], s[0:1], 88
    v_lshrrev_b32 v1, 6, v0
    v_and_b32 v0, 63, v0
    s_nop 0
    v_readfirstlane_b32 s3, v1
    s_and_b32 s24, s2, 7
    s_lshl_b32 s24, s24, 2
    s_bfe_u32 s25, s2, 0x20003
    s_add_u32 s24, s24, s25
    s_lshr_b32 s25, s2, 5
    v_and_b32 v1, 3, v0
    v_and_b32 v2, 15, v0
    v_lshrrev_b32 v14, 4, v0
    s_lshl_b32 s26, s24, 6
    s_lshl_b32 s27, s3, 2
    s_add_u32 s26, s26, s27
    s_lshl_b32 s26, s26, 10
    v_lshlrev_b32 v3, 10, v14
    v_lshl_add_u32 v3, v2, 4, v3
    s_waitcnt lgkmcnt(0)
    s_mov_b32 s28, s4
    s_mov_b32 s29, s5
    s_mov_b32 s30, 2097152
    s_mov_b32 s31, 0x00020000
    s_mov_b32 s32, s6
    s_mov_b32 s33, s7
    s_mov_b32 s34, 524288
    s_mov_b32 s35, 0x00020000
    s_mov_b32 s36, s8
    s_mov_b32 s37, s9
    s_mov_b32 s38, 16384
    s_mov_b32 s39, 0x00020000
    s_mov_b32 s40, s10
    s_mov_b32 s41, s11
    s_mov_b32 s42, 16384
    s_mov_b32 s43, 0x00020000
    s_mov_b32 s44, s22
    s_mov_b32 s45, s23
    s_mov_b32 s46, 20971520
    s_mov_b32 s47, 0x00020000
    buffer_load_dwordx4 v[16:19], v3, s[28:31], s26 offen offset:0
    buffer_load_dwordx4 v[20:23], v3, s[28:31], s26 offen offset:256
    buffer_load_dwordx4 v[24:27], v3, s[28:31], s26 offen offset:512
    buffer_load_dwordx4 v[28:31], v3, s[28:31], s26 offen offset:768
    v_lshrrev_b32 v4, 3, v0
    v_and_b32 v5, 7, v0
    v_and_b32 v6, 16, v0
    v_lshrrev_b32 v6, 2, v6
    v_xor_b32 v5, v5, v6
    v_lshlrev_b32 v4, 10, v4
    v_lshl_add_u32 v4, v5, 4, v4
    s_lshl_b32 s48, s3, 15
    s_lshl_b32 s49, s25, 7
    s_add_u32 s48, s48, s49
    s_lshl_b32 s49, s3, 12
    s_add_u32 s49, s49, 67584
    s_waitcnt vmcnt(0)
    s_mov_b32 m0, s49
    s_add_u32 s49, s49, 1024
    buffer_load_dwordx4 v4, s[32:35], s48 offen lds
    s_add_u32 s48, s48, 8192
    s_mov_b32 m0, s49
    s_add_u32 s49, s49, 1024
    buffer_load_dwordx4 v4, s[32:35], s48 offen lds
    s_add_u32 s48, s48, 8192
    s_mov_b32 m0, s49
    s_add_u32 s49, s49, 1024
    buffer_load_dwordx4 v4, s[32:35], s48 offen lds
    s_add_u32 s48, s48, 8192
    s_mov_b32 m0, s49
    s_add_u32 s49, s49, 1024
    buffer_load_dwordx4 v4, s[32:35], s48 offen lds
    s_add_u32 s48, s48, 8192
    v_lshlrev_b32 v7, 4, v0
    s_cmp_ge_u32 s25, 4
    s_cbranch_scc1 k1_nokv
    s_lshl_b32 s48, s3, 10
    s_add_u32 s49, s48, 133120
    s_mov_b32 m0, s49
    s_cmp_ge_u32 s25, 2
    s_cbranch_scc1 k1_ldv
    buffer_load_dwordx4 v7, s[36:39], s48 offen lds
    s_branch k1_nokv
k1_ldv:
    buffer_load_dwordx4 v7, s[40:43], s48 offen lds
k1_nokv:
    s_mov_b32 s50, 0
    s_cmp_lt_u32 s3, 8
    s_cbranch_scc1 k1_ln
    s_sub_u32 s51, s3, 8
    s_lshl_b32 s51, s51, 8
    s_add_u32 s51, s51, s2
    s_cmp_ge_u32 s51, 580
    s_cbranch_scc1 k1_ln
    s_mov_b32 s50, 1
    s_cmp_ge_u32 s51, 344
    s_cbranch_scc1 k1_w2
    s_mov_b32 s52, 0
    s_mov_b32 s56, s16
    s_mov_b32 s57, s17
    s_mov_b32 s58, 1409024
    s_mov_b32 s59, 0x00020000
    s_cmp_lt_u32 s51, 172
    s_cbranch_scc1 k1_gu
    s_sub_u32 s51, s51, 172
    s_mov_b32 s52, 1024
    s_mov_b32 s56, s18
    s_mov_b32 s57, s19
    s_mov_b32 s58, 1409024
    s_mov_b32 s59, 0x00020000
k1_gu:
    s_lshl_b32 s51, s51, 6
    v_add_u32 v8, s51, v0
    v_mul_u32_u24 v9, 24386, v8
    v_lshrrev_b32 v9, 22, v9
    v_mul_u32_u24 v10, 172, v9
    v_sub_u32 v10, v8, v10
    v_mul_u32_u24 v11, 22016, v9
    v_lshl_add_u32 v11, v10, 4, v11
    v_lshrrev_b32 v12, 2, v10
    v_lshlrev_b32 v12, 16, v12
    v_lshrrev_b32 v13, 1, v9
    v_lshl_add_u32 v12, v13, 11, v12
    v_and_b32 v13, 1, v9
    v_lshl_add_u32 v12, v13, 9, v12
    v_and_b32 v13, 3, v10
    v_lshl_add_u32 v12, v13, 7, v12
    s_add_u32 s52, s52, 5242880
    s_mov_b32 s60, 0
    s_mov_b32 s61, 2752
    s_mov_b32 s62, 5504
    s_mov_b32 s63, 8256
    s_mov_b32 s64, 11008
    s_mov_b32 s65, 13760
    s_mov_b32 s66, 16512
    s_mov_b32 s67, 19264
    s_branch k1_rl
k1_w2:
    s_sub_u32 s51, s51, 344
    s_mov_b32 s53, 0
    s_mov_b32 s56, s12
    s_mov_b32 s57, s13
    s_mov_b32 s58, 524288
    s_mov_b32 s59, 0x00020000
    s_cmp_lt_u32 s51, 64
    s_cbranch_scc1 k1_w2b
    s_sub_u32 s51, s51, 64
    s_mov_b32 s53, 32
    s_mov_b32 s56, s20
    s_mov_b32 s57, s21
    s_mov_b32 s58, 1409024
    s_mov_b32 s59, 0x00020000
k1_w2b:
    s_lshr_b32 s54, s51, 1
    s_and_b32 s55, s51, 1
    s_lshl_b32 s52, s54, 14
    s_lshl_b32 s51, s55, 12
    s_add_u32 s51, s51, s52
    v_add_u32 v11, s51, v7
    s_add_u32 s53, s53, s54
    s_lshl_b32 s53, s53, 10
    s_lshl_b32 s55, s55, 9
    s_add_u32 s52, s53, s55
    s_add_u32 s52, s52, 8388608
    v_lshrrev_b32 v12, 2, v0
    v_mul_u32_u24 v12, 120832, v12
    v_and_b32 v13, 3, v0
    v_lshl_add_u32 v12, v13, 7, v12
    s_mov_b32 s60, 0
    s_mov_b32 s61, 1024
    s_mov_b32 s62, 2048
    s_mov_b32 s63, 3072
    s_mov_b32 s64, 8192
    s_mov_b32 s65, 9216
    s_mov_b32 s66, 10240
    s_mov_b32 s67, 11264
k1_rl:
    buffer_load_dwordx4 v[64:67], v11, s[56:59], s60 offen
    buffer_load_dwordx4 v[68:71], v11, s[56:59], s61 offen
    buffer_load_dwordx4 v[72:75], v11, s[56:59], s62 offen
    buffer_load_dwordx4 v[76:79], v11, s[56:59], s63 offen
    buffer_load_dwordx4 v[80:83], v11, s[56:59], s64 offen
    buffer_load_dwordx4 v[84:87], v11, s[56:59], s65 offen
    buffer_load_dwordx4 v[88:91], v11, s[56:59], s66 offen
    buffer_load_dwordx4 v[92:95], v11, s[56:59], s67 offen
    s_branch k1_ln2
k1_ln:
k1_ln2:
    v_lshlrev_b32 v32, 16, v16
    v_and_b32 v33, 0xffff0000, v16
    v_lshlrev_b32 v34, 16, v17
    v_and_b32 v35, 0xffff0000, v17
    v_lshlrev_b32 v36, 16, v18
    v_and_b32 v37, 0xffff0000, v18
    v_lshlrev_b32 v38, 16, v19
    v_and_b32 v39, 0xffff0000, v19
    v_lshlrev_b32 v40, 16, v20
    v_and_b32 v41, 0xffff0000, v20
    v_lshlrev_b32 v42, 16, v21
    v_and_b32 v43, 0xffff0000, v21
    v_lshlrev_b32 v44, 16, v22
    v_and_b32 v45, 0xffff0000, v22
    v_lshlrev_b32 v46, 16, v23
    v_and_b32 v47, 0xffff0000, v23
    v_lshlrev_b32 v48, 16, v24
    v_and_b32 v49, 0xffff0000, v24
    v_lshlrev_b32 v50, 16, v25
    v_and_b32 v51, 0xffff0000, v25
    v_lshlrev_b32 v52, 16, v26
    v_and_b32 v53, 0xffff0000, v26
    v_lshlrev_b32 v54, 16, v27
    v_and_b32 v55, 0xffff0000, v27
    v_lshlrev_b32 v56, 16, v28
    v_and_b32 v57, 0xffff0000, v28
    v_lshlrev_b32 v58, 16, v29
    v_and_b32 v59, 0xffff0000, v29
    v_lshlrev_b32 v60, 16, v30
    v_and_b32 v61, 0xffff0000, v30
    v_lshlrev_b32 v62, 16, v31
    v_and_b32 v63, 0xffff0000, v31
    v_pk_add_f32 v[16:17], v[32:33], v[36:37]
    v_pk_add_f32 v[18:19], v[34:35], v[38:39]
    v_pk_add_f32 v[16:17], v[16:17], v[40:41]
    v_pk_add_f32 v[18:19], v[18:19], v[42:43]
    v_pk_add_f32 v[16:17], v[16:17], v[44:45]
    v_pk_add_f32 v[18:19], v[18:19], v[46:47]
    v_pk_add_f32 v[16:17], v[16:17], v[48:49]
    v_pk_add_f32 v[18:19], v[18:19], v[50:51]
    v_pk_add_f32 v[16:17], v[16:17], v[52:53]
    v_pk_add_f32 v[18:19], v[18:19], v[54:55]
    v_pk_add_f32 v[16:17], v[16:17], v[56:57]
    v_pk_add_f32 v[18:19], v[18:19], v[58:59]
    v_pk_add_f32 v[16:17], v[16:17], v[60:61]
    v_pk_add_f32 v[18:19], v[18:19], v[62:63]
    v_add_f32 v16, v16, v17
    v_add_f32 v18, v18, v19
    v_add_f32 v16, v16, v18
    s_nop 1
    v_add_f32_dpp v16, v16, v16 quad_perm:[1,0,3,2] row_mask:0xf bank_mask:0xf
    s_nop 1
    v_add_f32_dpp v16, v16, v16 quad_perm:[2,3,0,1] row_mask:0xf bank_mask:0xf
    s_nop 1
    v_mov_b32_dpp v17, v16 row_ror:4 row_mask:0xf bank_mask:0xf
    v_add_f32 v16, v16, v17
    s_nop 1
    v_mov_b32_dpp v17, v16 row_ror:8 row_mask:0xf bank_mask:0xf
    v_add_f32 v16, v16, v17
    v_mul_f32 v16, 0x3b000000, v16
    v_sub_f32 v18, 0, v16
    v_sub_f32 v19, 0, v16
    v_pk_add_f32 v[24:25], v[32:33], v[18:19]
    v_pk_mul_f32 v[20:21], v[24:25], v[24:25]
    v_pk_add_f32 v[26:27], v[34:35], v[18:19]
    v_pk_mul_f32 v[22:23], v[26:27], v[26:27]
    v_pk_add_f32 v[28:29], v[36:37], v[18:19]
    v_pk_fma_f32 v[20:21], v[28:29], v[28:29], v[20:21]
    v_pk_add_f32 v[30:31], v[38:39], v[18:19]
    v_pk_fma_f32 v[22:23], v[30:31], v[30:31], v[22:23]
    v_pk_add_f32 v[24:25], v[40:41], v[18:19]
    v_pk_fma_f32 v[20:21], v[24:25], v[24:25], v[20:21]
    v_pk_add_f32 v[26:27], v[42:43], v[18:19]
    v_pk_fma_f32 v[22:23], v[26:27], v[26:27], v[22:23]
    v_pk_add_f32 v[28:29], v[44:45], v[18:19]
    v_pk_fma_f32 v[20:21], v[28:29], v[28:29], v[20:21]
    v_pk_add_f32 v[30:31], v[46:47], v[18:19]
    v_pk_fma_f32 v[22:23], v[30:31], v[30:31], v[22:23]
    v_pk_add_f32 v[24:25], v[48:49], v[18:19]
    v_pk_fma_f32 v[20:21], v[24:25], v[24:25], v[20:21]
    v_pk_add_f32 v[26:27], v[50:51], v[18:19]
    v_pk_fma_f32 v[22:23], v[26:27], v[26:27], v[22:23]
    v_pk_add_f32 v[28:29], v[52:53], v[18:19]
    v_pk_fma_f32 v[20:21], v[28:29], v[28:29], v[20:21]
    v_pk_add_f32 v[30:31], v[54:55], v[18:19]
    v_pk_fma_f32 v[22:23], v[30:31], v[30:31], v[22:23]
    v_pk_add_f32 v[24:25], v[56:57], v[18:19]
    v_pk_fma_f32 v[20:21], v[24:25], v[24:25], v[20:21]
    v_pk_add_f32 v[26:27], v[58:59], v[18:19]
    v_pk_fma_f32 v[22:23], v[26:27], v[26:27], v[22:23]
    v_pk_add_f32 v[28:29], v[60:61], v[18:19]
    v_pk_fma_f32 v[20:21], v[28:29], v[28:29], v[20:21]
    v_pk_add_f32 v[30:31], v[62:63], v[18:19]
    v_pk_fma_f32 v[22:23], v[30:31], v[30:31], v[22:23]
    v_add_f32 v20, v20, v21
    v_add_f32 v22, v22, v23
    v_add_f32 v20, v20, v22
    s_nop 1
    v_add_f32_dpp v20, v20, v20 quad_perm:[1,0,3,2] row_mask:0xf bank_mask:0xf
    s_nop 1
    v_add_f32_dpp v20, v20, v20 quad_perm:[2,3,0,1] row_mask:0xf bank_mask:0xf
    s_nop 1
    v_mov_b32_dpp v21, v20 row_ror:4 row_mask:0xf bank_mask:0xf
    v_add_f32 v20, v20, v21
    s_nop 1
    v_mov_b32_dpp v21, v20 row_ror:8 row_mask:0xf bank_mask:0xf
    v_add_f32 v20, v20, v21
    v_mul_f32 v20, 0x3b000000, v20
    v_cvt_pk_bf16_f32 v16, v16, v16
    v_and_b32 v16, 0xffff0000, v16
    v_cvt_pk_bf16_f32 v20, v20, v20
    v_and_b32 v20, 0xffff0000, v20
    v_add_f32 v20, 0x3727c5ac, v20
    v_cvt_pk_bf16_f32 v20, v20, v20
    v_and_b32 v20, 0xffff0000, v20
    v_sqrt_f32 v20, v20
    s_nop 0
    v_cvt_pk_bf16_f32 v20, v20, v20
    v_and_b32 v20, 0xffff0000, v20
    v_rcp_f32 v20, v20
    s_nop 0
    v_mul_f32 v22, v16, v20
    v_sub_f32 v22, 0, v22
    v_mov_b32 v21, v20
    v_mov_b32 v23, v22
    v_pk_fma_f32 v[32:33], v[32:33], v[20:21], v[22:23]
    v_pk_fma_f32 v[34:35], v[34:35], v[20:21], v[22:23]
    v_pk_fma_f32 v[36:37], v[36:37], v[20:21], v[22:23]
    v_pk_fma_f32 v[38:39], v[38:39], v[20:21], v[22:23]
    v_pk_fma_f32 v[40:41], v[40:41], v[20:21], v[22:23]
    v_pk_fma_f32 v[42:43], v[42:43], v[20:21], v[22:23]
    v_pk_fma_f32 v[44:45], v[44:45], v[20:21], v[22:23]
    v_pk_fma_f32 v[46:47], v[46:47], v[20:21], v[22:23]
    v_pk_fma_f32 v[48:49], v[48:49], v[20:21], v[22:23]
    v_pk_fma_f32 v[50:51], v[50:51], v[20:21], v[22:23]
    v_pk_fma_f32 v[52:53], v[52:53], v[20:21], v[22:23]
    v_pk_fma_f32 v[54:55], v[54:55], v[20:21], v[22:23]
    v_pk_fma_f32 v[56:57], v[56:57], v[20:21], v[22:23]
    v_pk_fma_f32 v[58:59], v[58:59], v[20:21], v[22:23]
    v_pk_fma_f32 v[60:61], v[60:61], v[20:21], v[22:23]
    v_pk_fma_f32 v[62:63], v[62:63], v[20:21], v[22:23]
    v_cvt_pk_bf16_f32 v16, v32, v33
    v_cvt_pk_bf16_f32 v17, v34, v35
    v_cvt_pk_bf16_f32 v18, v36, v37
    v_cvt_pk_bf16_f32 v19, v38, v39
    v_cvt_pk_bf16_f32 v20, v40, v41
    v_cvt_pk_bf16_f32 v21, v42, v43
    v_cvt_pk_bf16_f32 v22, v44, v45
    v_cvt_pk_bf16_f32 v23, v46, v47
    v_cvt_pk_bf16_f32 v24, v48, v49
    v_cvt_pk_bf16_f32 v25, v50, v51
    v_cvt_pk_bf16_f32 v26, v52, v53
    v_cvt_pk_bf16_f32 v27, v54, v55
    v_cvt_pk_bf16_f32 v28, v56, v57
    v_cvt_pk_bf16_f32 v29, v58, v59
    v_cvt_pk_bf16_f32 v30, v60, v61
    v_cvt_pk_bf16_f32 v31, v62, v63
    s_lshr_b32 s48, s3, 3
    s_mul_i32 s48, s48, 33792
    s_and_b32 s49, s3, 7
    s_lshl_b32 s49, s49, 6
    s_add_u32 s48, s48, s49
    v_mul_u32_u24 v4, 528, v2
    v_lshl_add_u32 v4, v14, 4, v4
    v_add_u32 v4, s48, v4
    ds_write_b128 v4, v[16:19] offset:0
    ds_write_b128 v4, v[20:23] offset:8448
    ds_write_b128 v4, v[24:27] offset:16896
    ds_write_b128 v4, v[28:31] offset:25344
    v_lshrrev_b32 v15, 5, v0
    v_lshl_add_u32 v15, v15, 4, v7
    s_cmp_lg_u32 s50, 0
    s_cbranch_scc1 k1_bw
    s_waitcnt vmcnt(0)
k1_bw:
    s_waitcnt vmcnt(8) lgkmcnt(0)
    s_barrier
    s_cmp_ge_u32 s3, 8
    s_cbranch_scc1 k1_rfin
    s_cmp_ge_u32 s3, 4
    s_cbranch_scc1 k1_aux
    v_bfe_u32 v8, v0, 2, 2
    v_bfe_u32 v9, v0, 4, 1
    v_lshrrev_b32 v10, 5, v0
    v_lshl_add_u32 v10, v10, 3, v8
    s_and_b32 s48, s3, 1
    s_lshr_b32 s49, s3, 1
    s_lshl_b32 s51, s48, 6
    v_lshlrev_b32 v11, 3, v1
    v_lshl_add_u32 v11, v9, 5, v11
    v_add_u32 v11, s51, v11
    v_and_b32 v12, 8, v0
    v_lshlrev_b32 v12, 3, v12
    v_xor_b32 v11, v11, v12
    v_lshl_add_u32 v11, v10, 7, v11
    v_add_u32 v11, 67584, v11
    s_mul_i32 s51, s49, 33792
    v_add_u32 v12, s51, v15
    v_mov_b32 v32, 0
    v_mov_b32 v33, 0
    v_mov_b32 v34, 0
    v_mov_b32 v35, 0
    v_mov_b32 v36, 0
    v_mov_b32 v37, 0
    v_mov_b32 v38, 0
    v_mov_b32 v39, 0
    v_mov_b32 v40, 0
    v_mov_b32 v41, 0
    v_mov_b32 v42, 0
    v_mov_b32 v43, 0
    v_mov_b32 v44, 0
    v_mov_b32 v45, 0
    v_mov_b32 v46, 0
    v_mov_b32 v47, 0
    ds_read_b64_tr_b16 v[64:65], v11 offset:0
    ds_read_b64_tr_b16 v[66:67], v11 offset:512
    ds_read_b128 v[68:71], v12 offset:0
    ds_read_b64_tr_b16 v[72:73], v11 offset:2048
    ds_read_b64_tr_b16 v[74:75], v11 offset:2560
    ds_read_b128 v[76:79], v12 offset:1056
    ds_read_b64_tr_b16 v[80:81], v11 offset:4096
    ds_read_b64_tr_b16 v[82:83], v11 offset:4608
    ds_read_b128 v[84:87], v12 offset:2112
    ds_read_b64_tr_b16 v[88:89], v11 offset:6144
    ds_read_b64_tr_b16 v[90:91], v11 offset:6656
    ds_read_b128 v[92:95], v12 offset:3168
    s_waitcnt lgkmcnt(9)
    v_mfma_f32_32x32x16_bf16 v[32:47], v[64:67], v[68:71], v[32:47]
    ds_read_b64_tr_b16 v[64:65], v11 offset:8192
    ds_read_b64_tr_b16 v[66:67], v11 offset:8704
    ds_read_b128 v[68:71], v12 offset:4224
    s_waitcnt lgkmcnt(9)
    v_mfma_f32_32x32x16_bf16 v[32:47], v[72:75], v[76:79], v[32:47]
    ds_read_b64_tr_b16 v[72:73], v11 offset:10240
    ds_read_b64_tr_b16 v[74:75], v11 offset:10752
    ds_read_b128 v[76:79], v12 offset:5280
    s_waitcnt lgkmcnt(9)
    v_mfma_f32_32x32x16_bf16 v[32:47], v[80:83], v[84:87], v[32:47]
    ds_read_b64_tr_b16 v[80:81], v11 offset:12288
    ds_read_b64_tr_b16 v[82:83], v11 offset:12800
    ds_read_b128 v[84:87], v12 offset:6336
    s_waitcnt lgkmcnt(9)
    v_mfma_f32_32x32x16_bf16 v[32:47], v[88:91], v[92:95], v[32:47]
    ds_read_b64_tr_b16 v[88:89], v11 offset:14336
    ds_read_b64_tr_b16 v[90:91], v11 offset:14848
    ds_read_b128 v[92:95], v12 offset:7392
    s_waitcnt lgkmcnt(9)
    v_mfma_f32_32x32x16_bf16 v[32:47], v[64:67], v[68:71], v[32:47]
    ds_read_b64_tr_b16 v[64:65], v11 offset:16384
    ds_read_b64_tr_b16 v[66:67], v11 offset:16896
    ds_read_b128 v[68:71], v12 offset:8448
    s_waitcnt lgkmcnt(9)
    v_mfma_f32_32x32x16_bf16 v[32:47], v[72:75], v[76:79], v[32:47]
    ds_read_b64_tr_b16 v[72:73], v11 offset:18432
    ds_read_b64_tr_b16 v[74:75], v11 offset:18944
    ds_read_b128 v[76:79], v12 offset:9504
    s_waitcnt lgkmcnt(9)
    v_mfma_f32_32x32x16_bf16 v[32:47], v[80:83], v[84:87], v[32:47]
    ds_read_b64_tr_b16 v[80:81], v11 offset:20480
    ds_read_b64_tr_b16 v[82:83], v11 offset:20992
    ds_read_b128 v[84:87], v12 offset:10560
    s_waitcnt lgkmcnt(9)
    v_mfma_f32_32x32x16_bf16 v[32:47], v[88:91], v[92:95], v[32:47]
    ds_read_b64_tr_b16 v[88:89], v11 offset:22528
    ds_read_b64_tr_b16 v[90:91], v11 offset:23040
    ds_read_b128 v[92:95], v12 offset:11616
    s_waitcnt lgkmcnt(9)
    v_mfma_f32_32x32x16_bf16 v[32:47], v[64:67], v[68:71], v[32:47]
    ds_read_b64_tr_b16 v[64:65], v11 offset:24576
    ds_read_b64_tr_b16 v[66:67], v11 offset:25088
    ds_read_b128 v[68:71], v12 offset:12672
    s_waitcnt lgkmcnt(9)
    v_mfma_f32_32x32x16_bf16 v[32:47], v[72:75], v[76:79], v[32:47]
    ds_read_b64_tr_b16 v[72:73], v11 offset:26624
    ds_read_b64_tr_b16 v[74:75], v11 offset:27136
    ds_read_b128 v[76:79], v12 offset:13728
    s_waitcnt lgkmcnt(9)
    v_mfma_f32_32x32x16_bf16 v[32:47], v[80:83], v[84:87], v[32:47]
    ds_read_b64_tr_b16 v[80:81], v11 offset:28672
    ds_read_b64_tr_b16 v[82:83], v11 offset:29184
    ds_read_b128 v[84:87], v12 offset:14784
    s_waitcnt lgkmcnt(9)
    v_mfma_f32_32x32x16_bf16 v[32:47], v[88:91], v[92:95], v[32:47]
    ds_read_b64_tr_b16 v[88:89], v11 offset:30720
    ds_read_b64_tr_b16 v[90:91], v11 offset:31232
    ds_read_b128 v[92:95], v12 offset:15840
    s_waitcnt lgkmcnt(9)
    v_mfma_f32_32x32x16_bf16 v[32:47], v[64:67], v[68:71], v[32:47]
    ds_read_b64_tr_b16 v[64:65], v11 offset:32768
    ds_read_b64_tr_b16 v[66:67], v11 offset:33280
    ds_read_b128 v[68:71], v12 offset:16896
    s_waitcnt lgkmcnt(9)
    v_mfma_f32_32x32x16_bf16 v[32:47], v[72:75], v[76:79], v[32:47]
    ds_read_b64_tr_b16 v[72:73], v11 offset:34816
    ds_read_b64_tr_b16 v[74:75], v11 offset:35328
    ds_read_b128 v[76:79], v12 offset:17952
    s_waitcnt lgkmcnt(9)
    v_mfma_f32_32x32x16_bf16 v[32:47], v[80:83], v[84:87], v[32:47]
    ds_read_b64_tr_b16 v[80:81], v11 offset:36864
    ds_read_b64_tr_b16 v[82:83], v11 offset:37376
    ds_read_b128 v[84:87], v12 offset:19008
    s_waitcnt lgkmcnt(9)
    v_mfma_f32_32x32x16_bf16 v[32:47], v[88:91], v[92:95], v[32:47]
    ds_read_b64_tr_b16 v[88:89], v11 offset:38912
    ds_read_b64_tr_b16 v[90:91], v11 offset:39424
    ds_read_b128 v[92:95], v12 offset:20064
    s_waitcnt lgkmcnt(9)
    v_mfma_f32_32x32x16_bf16 v[32:47], v[64:67], v[68:71], v[32:47]
    ds_read_b64_tr_b16 v[64:65], v11 offset:40960
    ds_read_b64_tr_b16 v[66:67], v11 offset:41472
    ds_read_b128 v[68:71], v12 offset:21120
    s_waitcnt lgkmcnt(9)
    v_mfma_f32_32x32x16_bf16 v[32:47], v[72:75], v[76:79], v[32:47]
    ds_read_b64_tr_b16 v[72:73], v11 offset:43008
    ds_read_b64_tr_b16 v[74:75], v11 offset:43520
    ds_read_b128 v[76:79], v12 offset:22176
    s_waitcnt lgkmcnt(9)
    v_mfma_f32_32x32x16_bf16 v[32:47], v[80:83], v[84:87], v[32:47]
    ds_read_b64_tr_b16 v[80:81], v11 offset:45056
    ds_read_b64_tr_b16 v[82:83], v11 offset:45568
    ds_read_b128 v[84:87], v12 offset:23232
    s_waitcnt lgkmcnt(9)
    v_mfma_f32_32x32x16_bf16 v[32:47], v[88:91], v[92:95], v[32:47]
    ds_read_b64_tr_b16 v[88:89], v11 offset:47104
    ds_read_b64_tr_b16 v[90:91], v11 offset:47616
    ds_read_b128 v[92:95], v12 offset:24288
    s_waitcnt lgkmcnt(9)
    v_mfma_f32_32x32x16_bf16 v[32:47], v[64:67], v[68:71], v[32:47]
    ds_read_b64_tr_b16 v[64:65], v11 offset:49152
    ds_read_b64_tr_b16 v[66:67], v11 offset:49664
    ds_read_b128 v[68:71], v12 offset:25344
    s_waitcnt lgkmcnt(9)
    v_mfma_f32_32x32x16_bf16 v[32:47], v[72:75], v[76:79], v[32:47]
    ds_read_b64_tr_b16 v[72:73], v11 offset:51200
    ds_read_b64_tr_b16 v[74:75], v11 offset:51712
    ds_read_b128 v[76:79], v12 offset:26400
    s_waitcnt lgkmcnt(9)
    v_mfma_f32_32x32x16_bf16 v[32:47], v[80:83], v[84:87], v[32:47]
    ds_read_b64_tr_b16 v[80:81], v11 offset:53248
    ds_read_b64_tr_b16 v[82:83], v11 offset:53760
    ds_read_b128 v[84:87], v12 offset:27456
    s_waitcnt lgkmcnt(9)
    v_mfma_f32_32x32x16_bf16 v[32:47], v[88:91], v[92:95], v[32:47]
    ds_read_b64_tr_b16 v[88:89], v11 offset:55296
    ds_read_b64_tr_b16 v[90:91], v11 offset:55808
    ds_read_b128 v[92:95], v12 offset:28512
    s_waitcnt lgkmcnt(9)
    v_mfma_f32_32x32x16_bf16 v[32:47], v[64:67], v[68:71], v[32:47]
    ds_read_b64_tr_b16 v[64:65], v11 offset:57344
    ds_read_b64_tr_b16 v[66:67], v11 offset:57856
    ds_read_b128 v[68:71], v12 offset:29568
    s_waitcnt lgkmcnt(9)
    v_mfma_f32_32x32x16_bf16 v[32:47], v[72:75], v[76:79], v[32:47]
    ds_read_b64_tr_b16 v[72:73], v11 offset:59392
    ds_read_b64_tr_b16 v[74:75], v11 offset:59904
    ds_read_b128 v[76:79], v12 offset:30624
    s_waitcnt lgkmcnt(9)
    v_mfma_f32_32x32x16_bf16 v[32:47], v[80:83], v[84:87], v[32:47]
    ds_read_b64_tr_b16 v[80:81], v11 offset:61440
    ds_read_b64_tr_b16 v[82:83], v11 offset:61952
    ds_read_b128 v[84:87], v12 offset:31680
    s_waitcnt lgkmcnt(9)
    v_mfma_f32_32x32x16_bf16 v[32:47], v[88:91], v[92:95], v[32:47]
    ds_read_b64_tr_b16 v[88:89], v11 offset:63488
    ds_read_b64_tr_b16 v[90:91], v11 offset:64000
    ds_read_b128 v[92:95], v12 offset:32736
    s_waitcnt lgkmcnt(9)
    v_mfma_f32_32x32x16_bf16 v[32:47], v[64:67], v[68:71], v[32:47]
    s_waitcnt lgkmcnt(6)
    v_mfma_f32_32x32x16_bf16 v[32:47], v[72:75], v[76:79], v[32:47]
    s_waitcnt lgkmcnt(3)
    v_mfma_f32_32x32x16_bf16 v[32:47], v[80:83], v[84:87], v[32:47]
    s_waitcnt lgkmcnt(0)
    v_mfma_f32_32x32x16_bf16 v[32:47], v[88:91], v[92:95], v[32:47]
    s_nop 15
    s_mov_b32 s51, 0x3eb8aa3b
    v_mul_f32 v32, s51, v32
    v_mul_f32 v33, s51, v33
    v_mul_f32 v34, s51, v34
    v_mul_f32 v35, s51, v35
    v_mul_f32 v36, s51, v36
    v_mul_f32 v37, s51, v37
    v_mul_f32 v38, s51, v38
    v_mul_f32 v39, s51, v39
    v_mul_f32 v40, s51, v40
    v_mul_f32 v41, s51, v41
    v_mul_f32 v42, s51, v42
    v_mul_f32 v43, s51, v43
    v_mul_f32 v44, s51, v44
    v_mul_f32 v45, s51, v45
    v_mul_f32 v46, s51, v46
    v_mul_f32 v47, s51, v47
    v_cvt_pk_bf16_f32 v48, v32, v33
    v_cvt_pk_bf16_f32 v49, v34, v35
    v_cvt_pk_bf16_f32 v50, v36, v37
    v_cvt_pk_bf16_f32 v51, v38, v39
    v_cvt_pk_bf16_f32 v52, v40, v41
    v_cvt_pk_bf16_f32 v53, v42, v43
    v_cvt_pk_bf16_f32 v54, v44, v45
    v_cvt_pk_bf16_f32 v55, v46, v47
    s_lshl_b32 s51, s24, 1
    s_add_u32 s51, s51, s49
    s_lshl_b32 s51, s51, 5
    s_lshl_b32 s52, s25, 2
    s_add_u32 s51, s51, s52
    s_lshl_b32 s52, s48, 1
    s_add_u32 s51, s51, s52
    s_lshl_b32 s51, s51, 10
    s_add_u32 s51, s51, 2097152
    buffer_store_dwordx4 v[48:51], v7, s[44:47], s51 offen sc0 sc1
    buffer_store_dwordx4 v[52:55], v7, s[44:47], s51 offen offset:1024 sc0 sc1
    s_waitcnt vmcnt(0)
    s_endpgm
k1_aux:
    s_cmp_ge_u32 s25, 4
    s_cbranch_scc1 k1_xn
    s_cmp_lg_u32 s3, 4
    s_cbranch_scc1 k1_end
    v_bfe_u32 v8, v0, 2, 2
    v_bfe_u32 v9, v0, 4, 1
    v_lshrrev_b32 v10, 5, v0
    v_lshl_add_u32 v10, v10, 3, v8
    v_lshlrev_b32 v11, 3, v1
    v_lshl_add_u32 v11, v10, 5, v11
    v_add_u32 v11, 133120, v11
    s_and_b32 s49, s25, 1
    s_mul_i32 s51, s49, 33792
    v_add_u32 v12, s51, v15
    s_lshl_b32 s51, s24, 1
    s_add_u32 s49, s51, s49
    s_lshl_b32 s51, s49, 11
    s_add_u32 s51, s51, 4194304
    s_cmp_ge_u32 s25, 2
    s_cbranch_scc1 k1_v
    v_mov_b32 v32, 0
    v_mov_b32 v33, 0
    v_mov_b32 v34, 0
    v_mov_b32 v35, 0
    v_mov_b32 v36, 0
    v_mov_b32 v37, 0
    v_mov_b32 v38, 0
    v_mov_b32 v39, 0
    v_mov_b32 v40, 0
    v_mov_b32 v41, 0
    v_mov_b32 v42, 0
    v_mov_b32 v43, 0
    v_mov_b32 v44, 0
    v_mov_b32 v45, 0
    v_mov_b32 v46, 0
    v_mov_b32 v47, 0
    ds_read_b64_tr_b16 v[64:65], v11 offset:0
    ds_read_b64_tr_b16 v[66:67], v11 offset:128
    ds_read_b128 v[68:71], v12 offset:0
    ds_read_b64_tr_b16 v[72:73], v11 offset:512
    ds_read_b64_tr_b16 v[74:75], v11 offset:640
    ds_read_b128 v[76:79], v12 offset:1056
    ds_read_b64_tr_b16 v[80:81], v11 offset:1024
    ds_read_b64_tr_b16 v[82:83], v11 offset:1152
    ds_read_b128 v[84:87], v12 offset:2112
    ds_read_b64_tr_b16 v[88:89], v11 offset:1536
    ds_read_b64_tr_b16 v[90:91], v11 offset:1664
    ds_read_b128 v[92:95], v12 offset:3168
    s_waitcnt lgkmcnt(9)
    v_mfma_f32_32x32x16_bf16 v[32:47], v[64:67], v[68:71], v[32:47]
    ds_read_b64_tr_b16 v[64:65], v11 offset:2048
    ds_read_b64_tr_b16 v[66:67], v11 offset:2176
    ds_read_b128 v[68:71], v12 offset:4224
    s_waitcnt lgkmcnt(9)
    v_mfma_f32_32x32x16_bf16 v[32:47], v[72:75], v[76:79], v[32:47]
    ds_read_b64_tr_b16 v[72:73], v11 offset:2560
    ds_read_b64_tr_b16 v[74:75], v11 offset:2688
    ds_read_b128 v[76:79], v12 offset:5280
    s_waitcnt lgkmcnt(9)
    v_mfma_f32_32x32x16_bf16 v[32:47], v[80:83], v[84:87], v[32:47]
    ds_read_b64_tr_b16 v[80:81], v11 offset:3072
    ds_read_b64_tr_b16 v[82:83], v11 offset:3200
    ds_read_b128 v[84:87], v12 offset:6336
    s_waitcnt lgkmcnt(9)
    v_mfma_f32_32x32x16_bf16 v[32:47], v[88:91], v[92:95], v[32:47]
    ds_read_b64_tr_b16 v[88:89], v11 offset:3584
    ds_read_b64_tr_b16 v[90:91], v11 offset:3712
    ds_read_b128 v[92:95], v12 offset:7392
    s_waitcnt lgkmcnt(9)
    v_mfma_f32_32x32x16_bf16 v[32:47], v[64:67], v[68:71], v[32:47]
    ds_read_b64_tr_b16 v[64:65], v11 offset:4096
    ds_read_b64_tr_b16 v[66:67], v11 offset:4224
    ds_read_b128 v[68:71], v12 offset:8448
    s_waitcnt lgkmcnt(9)
    v_mfma_f32_32x32x16_bf16 v[32:47], v[72:75], v[76:79], v[32:47]
    ds_read_b64_tr_b16 v[72:73], v11 offset:4608
    ds_read_b64_tr_b16 v[74:75], v11 offset:4736
    ds_read_b128 v[76:79], v12 offset:9504
    s_waitcnt lgkmcnt(9)
    v_mfma_f32_32x32x16_bf16 v[32:47], v[80:83], v[84:87], v[32:47]
    ds_read_b64_tr_b16 v[80:81], v11 offset:5120
    ds_read_b64_tr_b16 v[82:83], v11 offset:5248
    ds_read_b128 v[84:87], v12 offset:10560
    s_waitcnt lgkmcnt(9)
    v_mfma_f32_32x32x16_bf16 v[32:47], v[88:91], v[92:95], v[32:47]
    ds_read_b64_tr_b16 v[88:89], v11 offset:5632
    ds_read_b64_tr_b16 v[90:91], v11 offset:5760
    ds_read_b128 v[92:95], v12 offset:11616
    s_waitcnt lgkmcnt(9)
    v_mfma_f32_32x32x16_bf16 v[32:47], v[64:67], v[68:71], v[32:47]
    ds_read_b64_tr_b16 v[64:65], v11 offset:6144
    ds_read_b64_tr_b16 v[66:67], v11 offset:6272
    ds_read_b128 v[68:71], v12 offset:12672
    s_waitcnt lgkmcnt(9)
    v_mfma_f32_32x32x16_bf16 v[32:47], v[72:75], v[76:79], v[32:47]
    ds_read_b64_tr_b16 v[72:73], v11 offset:6656
    ds_read_b64_tr_b16 v[74:75], v11 offset:6784
    ds_read_b128 v[76:79], v12 offset:13728
    s_waitcnt lgkmcnt(9)
    v_mfma_f32_32x32x16_bf16 v[32:47], v[80:83], v[84:87], v[32:47]
    ds_read_b64_tr_b16 v[80:81], v11 offset:7168
    ds_read_b64_tr_b16 v[82:83], v11 offset:7296
    ds_read_b128 v[84:87], v12 offset:14784
    s_waitcnt lgkmcnt(9)
    v_mfma_f32_32x32x16_bf16 v[32:47], v[88:91], v[92:95], v[32:47]
    ds_read_b64_tr_b16 v[88:89], v11 offset:7680
    ds_read_b64_tr_b16 v[90:91], v11 offset:7808
    ds_read_b128 v[92:95], v12 offset:15840
    s_waitcnt lgkmcnt(9)
    v_mfma_f32_32x32x16_bf16 v[32:47], v[64:67], v[68:71], v[32:47]
    ds_read_b64_tr_b16 v[64:65], v11 offset:8192
    ds_read_b64_tr_b16 v[66:67], v11 offset:8320
    ds_read_b128 v[68:71], v12 offset:16896
    s_waitcnt lgkmcnt(9)
    v_mfma_f32_32x32x16_bf16 v[32:47], v[72:75], v[76:79], v[32:47]
    ds_read_b64_tr_b16 v[72:73], v11 offset:8704
    ds_read_b64_tr_b16 v[74:75], v11 offset:8832
    ds_read_b128 v[76:79], v12 offset:17952
    s_waitcnt lgkmcnt(9)
    v_mfma_f32_32x32x16_bf16 v[32:47], v[80:83], v[84:87], v[32:47]
    ds_read_b64_tr_b16 v[80:81], v11 offset:9216
    ds_read_b64_tr_b16 v[82:83], v11 offset:9344
    ds_read_b128 v[84:87], v12 offset:19008
    s_waitcnt lgkmcnt(9)
    v_mfma_f32_32x32x16_bf16 v[32:47], v[88:91], v[92:95], v[32:47]
    ds_read_b64_tr_b16 v[88:89], v11 offset:9728
    ds_read_b64_tr_b16 v[90:91], v11 offset:9856
    ds_read_b128 v[92:95], v12 offset:20064
    s_waitcnt lgkmcnt(9)
    v_mfma_f32_32x32x16_bf16 v[32:47], v[64:67], v[68:71], v[32:47]
    ds_read_b64_tr_b16 v[64:65], v11 offset:10240
    ds_read_b64_tr_b16 v[66:67], v11 offset:10368
    ds_read_b128 v[68:71], v12 offset:21120
    s_waitcnt lgkmcnt(9)
    v_mfma_f32_32x32x16_bf16 v[32:47], v[72:75], v[76:79], v[32:47]
    ds_read_b64_tr_b16 v[72:73], v11 offset:10752
    ds_read_b64_tr_b16 v[74:75], v11 offset:10880
    ds_read_b128 v[76:79], v12 offset:22176
    s_waitcnt lgkmcnt(9)
    v_mfma_f32_32x32x16_bf16 v[32:47], v[80:83], v[84:87], v[32:47]
    ds_read_b64_tr_b16 v[80:81], v11 offset:11264
    ds_read_b64_tr_b16 v[82:83], v11 offset:11392
    ds_read_b128 v[84:87], v12 offset:23232
    s_waitcnt lgkmcnt(9)
    v_mfma_f32_32x32x16_bf16 v[32:47], v[88:91], v[92:95], v[32:47]
    ds_read_b64_tr_b16 v[88:89], v11 offset:11776
    ds_read_b64_tr_b16 v[90:91], v11 offset:11904
    ds_read_b128 v[92:95], v12 offset:24288
    s_waitcnt lgkmcnt(9)
    v_mfma_f32_32x32x16_bf16 v[32:47], v[64:67], v[68:71], v[32:47]
    ds_read_b64_tr_b16 v[64:65], v11 offset:12288
    ds_read_b64_tr_b16 v[66:67], v11 offset:12416
    ds_read_b128 v[68:71], v12 offset:25344
    s_waitcnt lgkmcnt(9)
    v_mfma_f32_32x32x16_bf16 v[32:47], v[72:75], v[76:79], v[32:47]
    ds_read_b64_tr_b16 v[72:73], v11 offset:12800
    ds_read_b64_tr_b16 v[74:75], v11 offset:12928
    ds_read_b128 v[76:79], v12 offset:26400
    s_waitcnt lgkmcnt(9)
    v_mfma_f32_32x32x16_bf16 v[32:47], v[80:83], v[84:87], v[32:47]
    ds_read_b64_tr_b16 v[80:81], v11 offset:13312
    ds_read_b64_tr_b16 v[82:83], v11 offset:13440
    ds_read_b128 v[84:87], v12 offset:27456
    s_waitcnt lgkmcnt(9)
    v_mfma_f32_32x32x16_bf16 v[32:47], v[88:91], v[92:95], v[32:47]
    ds_read_b64_tr_b16 v[88:89], v11 offset:13824
    ds_read_b64_tr_b16 v[90:91], v11 offset:13952
    ds_read_b128 v[92:95], v12 offset:28512
    s_waitcnt lgkmcnt(9)
    v_mfma_f32_32x32x16_bf16 v[32:47], v[64:67], v[68:71], v[32:47]
    ds_read_b64_tr_b16 v[64:65], v11 offset:14336
    ds_read_b64_tr_b16 v[66:67], v11 offset:14464
    ds_read_b128 v[68:71], v12 offset:29568
    s_waitcnt lgkmcnt(9)
    v_mfma_f32_32x32x16_bf16 v[32:47], v[72:75], v[76:79], v[32:47]
    ds_read_b64_tr_b16 v[72:73], v11 offset:14848
    ds_read_b64_tr_b16 v[74:75], v11 offset:14976
    ds_read_b128 v[76:79], v12 offset:30624
    s_waitcnt lgkmcnt(9)
    v_mfma_f32_32x32x16_bf16 v[32:47], v[80:83], v[84:87], v[32:47]
    ds_read_b64_tr_b16 v[80:81], v11 offset:15360
    ds_read_b64_tr_b16 v[82:83], v11 offset:15488
    ds_read_b128 v[84:87], v12 offset:31680
    s_waitcnt lgkmcnt(9)
    v_mfma_f32_32x32x16_bf16 v[32:47], v[88:91], v[92:95], v[32:47]
    ds_read_b64_tr_b16 v[88:89], v11 offset:15872
    ds_read_b64_tr_b16 v[90:91], v11 offset:16000
    ds_read_b128 v[92:95], v12 offset:32736
    s_waitcnt lgkmcnt(9)
    v_mfma_f32_32x32x16_bf16 v[32:47], v[64:67], v[68:71], v[32:47]
    s_waitcnt lgkmcnt(6)
    v_mfma_f32_32x32x16_bf16 v[32:47], v[72:75], v[76:79], v[32:47]
    s_waitcnt lgkmcnt(3)
    v_mfma_f32_32x32x16_bf16 v[32:47], v[80:83], v[84:87], v[32:47]
    s_waitcnt lgkmcnt(0)
    v_mfma_f32_32x32x16_bf16 v[32:47], v[88:91], v[92:95], v[32:47]
    s_nop 15
    v_cvt_pk_bf16_f32 v48, v32, v33
    v_cvt_pk_bf16_f32 v49, v34, v35
    v_cvt_pk_bf16_f32 v50, v36, v37
    v_cvt_pk_bf16_f32 v51, v38, v39
    buffer_store_dwordx4 v[48:51], v7, s[44:47], s51 offen sc0 sc1
    v_lshlrev_b32 v53, 16, v48
    v_mul_f32 v52, v53, v53
    v_and_b32 v53, 0xffff0000, v48
    v_fmac_f32 v52, v53, v53
    v_lshlrev_b32 v53, 16, v49
    v_fmac_f32 v52, v53, v53
    v_and_b32 v53, 0xffff0000, v49
    v_fmac_f32 v52, v53, v53
    v_lshlrev_b32 v53, 16, v50
    v_fmac_f32 v52, v53, v53
    v_and_b32 v53, 0xffff0000, v50
    v_fmac_f32 v52, v53, v53
    v_lshlrev_b32 v53, 16, v51
    v_fmac_f32 v52, v53, v53
    v_and_b32 v53, 0xffff0000, v51
    v_fmac_f32 v52, v53, v53
    s_nop 1
    v_mov_b32 v53, v52
    s_nop 1
    v_permlane32_swap_b32 v52, v53
    s_nop 1
    v_add_f32 v52, v52, v53
    s_nop 1
    v_max_f32_dpp v52, v52, v52 quad_perm:[1,0,3,2] row_mask:0xf bank_mask:0xf
    s_nop 1
    v_max_f32_dpp v52, v52, v52 quad_perm:[2,3,0,1] row_mask:0xf bank_mask:0xf
    s_nop 1
    v_mov_b32_dpp v53, v52 row_ror:4 row_mask:0xf bank_mask:0xf
    v_max_f32 v52, v52, v53
    s_nop 1
    v_mov_b32_dpp v53, v52 row_ror:8 row_mask:0xf bank_mask:0xf
    v_max_f32 v52, v52, v53
    s_nop 1
    v_mov_b32 v53, v52
    s_nop 1
    v_permlane16_swap_b32 v52, v53
    s_nop 1
    v_max_f32 v52, v52, v53
    s_lshl_b32 s49, s49, 2
    s_add_u32 s49, s49, 4325376
    v_mov_b32 v54, 0
    s_mov_b64 exec, 1
    buffer_store_dword v52, v54, s[44:47], s49 offen sc0 sc1
    s_endpgm
k1_v:
    v_mov_b32 v32, 0
    v_mov_b32 v33, 0
    v_mov_b32 v34, 0
    v_mov_b32 v35, 0
    v_mov_b32 v36, 0
    v_mov_b32 v37, 0
    v_mov_b32 v38, 0
    v_mov_b32 v39, 0
    v_mov_b32 v40, 0
    v_mov_b32 v41, 0
    v_mov_b32 v42, 0
    v_mov_b32 v43, 0
    v_mov_b32 v44, 0
    v_mov_b32 v45, 0
    v_mov_b32 v46, 0
    v_mov_b32 v47, 0
    ds_read_b64_tr_b16 v[64:65], v11 offset:0
    ds_read_b64_tr_b16 v[66:67], v11 offset:128
    ds_read_b128 v[68:71], v12 offset:0
    ds_read_b64_tr_b16 v[72:73], v11 offset:512
    ds_read_b64_tr_b16 v[74:75], v11 offset:640
    ds_read_b128 v[76:79], v12 offset:1056
    ds_read_b64_tr_b16 v[80:81], v11 offset:1024
    ds_read_b64_tr_b16 v[82:83], v11 offset:1152
    ds_read_b128 v[84:87], v12 offset:2112
    ds_read_b64_tr_b16 v[88:89], v11 offset:1536
    ds_read_b64_tr_b16 v[90:91], v11 offset:1664
    ds_read_b128 v[92:95], v12 offset:3168
    s_waitcnt lgkmcnt(9)
    v_mfma_f32_32x32x16_bf16 v[32:47], v[68:71], v[64:67], v[32:47]
    ds_read_b64_tr_b16 v[64:65], v11 offset:2048
    ds_read_b64_tr_b16 v[66:67], v11 offset:2176
    ds_read_b128 v[68:71], v12 offset:4224
    s_waitcnt lgkmcnt(9)
    v_mfma_f32_32x32x16_bf16 v[32:47], v[76:79], v[72:75], v[32:47]
    ds_read_b64_tr_b16 v[72:73], v11 offset:2560
    ds_read_b64_tr_b16 v[74:75], v11 offset:2688
    ds_read_b128 v[76:79], v12 offset:5280
    s_waitcnt lgkmcnt(9)
    v_mfma_f32_32x32x16_bf16 v[32:47], v[84:87], v[80:83], v[32:47]
    ds_read_b64_tr_b16 v[80:81], v11 offset:3072
    ds_read_b64_tr_b16 v[82:83], v11 offset:3200
    ds_read_b128 v[84:87], v12 offset:6336
    s_waitcnt lgkmcnt(9)
    v_mfma_f32_32x32x16_bf16 v[32:47], v[92:95], v[88:91], v[32:47]
    ds_read_b64_tr_b16 v[88:89], v11 offset:3584
    ds_read_b64_tr_b16 v[90:91], v11 offset:3712
    ds_read_b128 v[92:95], v12 offset:7392
    s_waitcnt lgkmcnt(9)
    v_mfma_f32_32x32x16_bf16 v[32:47], v[68:71], v[64:67], v[32:47]
    ds_read_b64_tr_b16 v[64:65], v11 offset:4096
    ds_read_b64_tr_b16 v[66:67], v11 offset:4224
    ds_read_b128 v[68:71], v12 offset:8448
    s_waitcnt lgkmcnt(9)
    v_mfma_f32_32x32x16_bf16 v[32:47], v[76:79], v[72:75], v[32:47]
    ds_read_b64_tr_b16 v[72:73], v11 offset:4608
    ds_read_b64_tr_b16 v[74:75], v11 offset:4736
    ds_read_b128 v[76:79], v12 offset:9504
    s_waitcnt lgkmcnt(9)
    v_mfma_f32_32x32x16_bf16 v[32:47], v[84:87], v[80:83], v[32:47]
    ds_read_b64_tr_b16 v[80:81], v11 offset:5120
    ds_read_b64_tr_b16 v[82:83], v11 offset:5248
    ds_read_b128 v[84:87], v12 offset:10560
    s_waitcnt lgkmcnt(9)
    v_mfma_f32_32x32x16_bf16 v[32:47], v[92:95], v[88:91], v[32:47]
    ds_read_b64_tr_b16 v[88:89], v11 offset:5632
    ds_read_b64_tr_b16 v[90:91], v11 offset:5760
    ds_read_b128 v[92:95], v12 offset:11616
    s_waitcnt lgkmcnt(9)
    v_mfma_f32_32x32x16_bf16 v[32:47], v[68:71], v[64:67], v[32:47]
    ds_read_b64_tr_b16 v[64:65], v11 offset:6144
    ds_read_b64_tr_b16 v[66:67], v11 offset:6272
    ds_read_b128 v[68:71], v12 offset:12672
    s_waitcnt lgkmcnt(9)
    v_mfma_f32_32x32x16_bf16 v[32:47], v[76:79], v[72:75], v[32:47]
    ds_read_b64_tr_b16 v[72:73], v11 offset:6656
    ds_read_b64_tr_b16 v[74:75], v11 offset:6784
    ds_read_b128 v[76:79], v12 offset:13728
    s_waitcnt lgkmcnt(9)
    v_mfma_f32_32x32x16_bf16 v[32:47], v[84:87], v[80:83], v[32:47]
    ds_read_b64_tr_b16 v[80:81], v11 offset:7168
    ds_read_b64_tr_b16 v[82:83], v11 offset:7296
    ds_read_b128 v[84:87], v12 offset:14784
    s_waitcnt lgkmcnt(9)
    v_mfma_f32_32x32x16_bf16 v[32:47], v[92:95], v[88:91], v[32:47]
    ds_read_b64_tr_b16 v[88:89], v11 offset:7680
    ds_read_b64_tr_b16 v[90:91], v11 offset:7808
    ds_read_b128 v[92:95], v12 offset:15840
    s_waitcnt lgkmcnt(9)
    v_mfma_f32_32x32x16_bf16 v[32:47], v[68:71], v[64:67], v[32:47]
    ds_read_b64_tr_b16 v[64:65], v11 offset:8192
    ds_read_b64_tr_b16 v[66:67], v11 offset:8320
    ds_read_b128 v[68:71], v12 offset:16896
    s_waitcnt lgkmcnt(9)
    v_mfma_f32_32x32x16_bf16 v[32:47], v[76:79], v[72:75], v[32:47]
    ds_read_b64_tr_b16 v[72:73], v11 offset:8704
    ds_read_b64_tr_b16 v[74:75], v11 offset:8832
    ds_read_b128 v[76:79], v12 offset:17952
    s_waitcnt lgkmcnt(9)
    v_mfma_f32_32x32x16_bf16 v[32:47], v[84:87], v[80:83], v[32:47]
    ds_read_b64_tr_b16 v[80:81], v11 offset:9216
    ds_read_b64_tr_b16 v[82:83], v11 offset:9344
    ds_read_b128 v[84:87], v12 offset:19008
    s_waitcnt lgkmcnt(9)
    v_mfma_f32_32x32x16_bf16 v[32:47], v[92:95], v[88:91], v[32:47]
    ds_read_b64_tr_b16 v[88:89], v11 offset:9728
    ds_read_b64_tr_b16 v[90:91], v11 offset:9856
    ds_read_b128 v[92:95], v12 offset:20064
    s_waitcnt lgkmcnt(9)
    v_mfma_f32_32x32x16_bf16 v[32:47], v[68:71], v[64:67], v[32:47]
    ds_read_b64_tr_b16 v[64:65], v11 offset:10240
    ds_read_b64_tr_b16 v[66:67], v11 offset:10368
    ds_read_b128 v[68:71], v12 offset:21120
    s_waitcnt lgkmcnt(9)
    v_mfma_f32_32x32x16_bf16 v[32:47], v[76:79], v[72:75], v[32:47]
    ds_read_b64_tr_b16 v[72:73], v11 offset:10752
    ds_read_b64_tr_b16 v[74:75], v11 offset:10880
    ds_read_b128 v[76:79], v12 offset:22176
    s_waitcnt lgkmcnt(9)
    v_mfma_f32_32x32x16_bf16 v[32:47], v[84:87], v[80:83], v[32:47]
    ds_read_b64_tr_b16 v[80:81], v11 offset:11264
    ds_read_b64_tr_b16 v[82:83], v11 offset:11392
    ds_read_b128 v[84:87], v12 offset:23232
    s_waitcnt lgkmcnt(9)
    v_mfma_f32_32x32x16_bf16 v[32:47], v[92:95], v[88:91], v[32:47]
    ds_read_b64_tr_b16 v[88:89], v11 offset:11776
    ds_read_b64_tr_b16 v[90:91], v11 offset:11904
    ds_read_b128 v[92:95], v12 offset:24288
    s_waitcnt lgkmcnt(9)
    v_mfma_f32_32x32x16_bf16 v[32:47], v[68:71], v[64:67], v[32:47]
    ds_read_b64_tr_b16 v[64:65], v11 offset:12288
    ds_read_b64_tr_b16 v[66:67], v11 offset:12416
    ds_read_b128 v[68:71], v12 offset:25344
    s_waitcnt lgkmcnt(9)
    v_mfma_f32_32x32x16_bf16 v[32:47], v[76:79], v[72:75], v[32:47]
    ds_read_b64_tr_b16 v[72:73], v11 offset:12800
    ds_read_b64_tr_b16 v[74:75], v11 offset:12928
    ds_read_b128 v[76:79], v12 offset:26400
    s_waitcnt lgkmcnt(9)
    v_mfma_f32_32x32x16_bf16 v[32:47], v[84:87], v[80:83], v[32:47]
    ds_read_b64_tr_b16 v[80:81], v11 offset:13312
    ds_read_b64_tr_b16 v[82:83], v11 offset:13440
    ds_read_b128 v[84:87], v12 offset:27456
    s_waitcnt lgkmcnt(9)
    v_mfma_f32_32x32x16_bf16 v[32:47], v[92:95], v[88:91], v[32:47]
    ds_read_b64_tr_b16 v[88:89], v11 offset:13824
    ds_read_b64_tr_b16 v[90:91], v11 offset:13952
    ds_read_b128 v[92:95], v12 offset:28512
    s_waitcnt lgkmcnt(9)
    v_mfma_f32_32x32x16_bf16 v[32:47], v[68:71], v[64:67], v[32:47]
    ds_read_b64_tr_b16 v[64:65], v11 offset:14336
    ds_read_b64_tr_b16 v[66:67], v11 offset:14464
    ds_read_b128 v[68:71], v12 offset:29568
    s_waitcnt lgkmcnt(9)
    v_mfma_f32_32x32x16_bf16 v[32:47], v[76:79], v[72:75], v[32:47]
    ds_read_b64_tr_b16 v[72:73], v11 offset:14848
    ds_read_b64_tr_b16 v[74:75], v11 offset:14976
    ds_read_b128 v[76:79], v12 offset:30624
    s_waitcnt lgkmcnt(9)
    v_mfma_f32_32x32x16_bf16 v[32:47], v[84:87], v[80:83], v[32:47]
    ds_read_b64_tr_b16 v[80:81], v11 offset:15360
    ds_read_b64_tr_b16 v[82:83], v11 offset:15488
    ds_read_b128 v[84:87], v12 offset:31680
    s_waitcnt lgkmcnt(9)
    v_mfma_f32_32x32x16_bf16 v[32:47], v[92:95], v[88:91], v[32:47]
    ds_read_b64_tr_b16 v[88:89], v11 offset:15872
    ds_read_b64_tr_b16 v[90:91], v11 offset:16000
    ds_read_b128 v[92:95], v12 offset:32736
    s_waitcnt lgkmcnt(9)
    v_mfma_f32_32x32x16_bf16 v[32:47], v[68:71], v[64:67], v[32:47]
    s_waitcnt lgkmcnt(6)
    v_mfma_f32_32x32x16_bf16 v[32:47], v[76:79], v[72:75], v[32:47]
    s_waitcnt lgkmcnt(3)
    v_mfma_f32_32x32x16_bf16 v[32:47], v[84:87], v[80:83], v[32:47]
    s_waitcnt lgkmcnt(0)
    v_mfma_f32_32x32x16_bf16 v[32:47], v[92:95], v[88:91], v[32:47]
    s_nop 15
    v_cvt_pk_bf16_f32 v48, v32, v33
    v_cvt_pk_bf16_f32 v49, v34, v35
    v_cvt_pk_bf16_f32 v50, v36, v37
    v_cvt_pk_bf16_f32 v51, v38, v39
    v_cvt_pk_bf16_f32 v52, v40, v41
    v_cvt_pk_bf16_f32 v53, v42, v43
    v_cvt_pk_bf16_f32 v54, v44, v45
    v_cvt_pk_bf16_f32 v55, v46, v47
    v_and_b32 v8, 15, v0
    v_lshrrev_b32 v9, 5, v0
    v_lshl_add_u32 v8, v9, 4, v8
    v_lshlrev_b32 v8, 4, v8
    s_mov_b32 exec_lo, 0xffff0000
    s_mov_b32 exec_hi, 0xffff0000
    buffer_store_dwordx4 v[48:51], v8, s[44:47], s51 offen offset:1024 sc0 sc1
    buffer_store_dwordx4 v[52:55], v8, s[44:47], s51 offen offset:1536 sc0 sc1
    s_endpgm
k1_xn:
    s_sub_u32 s48, s25, 4
    s_lshl_b32 s48, s48, 2
    s_add_u32 s48, s48, s3
    s_sub_u32 s48, s48, 4
    s_mul_i32 s49, s48, 4224
    s_lshl_b32 s48, s48, 12
    v_add_u32 v8, s49, v15
    ds_read_b128 v[16:19], v8 offset:0
    ds_read_b128 v[20:23], v8 offset:1056
    ds_read_b128 v[24:27], v8 offset:2112
    ds_read_b128 v[28:31], v8 offset:3168
    s_lshl_b32 s49, s24, 16
    s_add_u32 s48, s48, s49
    s_waitcnt lgkmcnt(3)
    buffer_store_dwordx4 v[16:19], v7, s[44:47], s48 offen offset:0 sc0 sc1
    s_waitcnt lgkmcnt(2)
    buffer_store_dwordx4 v[20:23], v7, s[44:47], s48 offen offset:1024 sc0 sc1
    s_waitcnt lgkmcnt(1)
    buffer_store_dwordx4 v[24:27], v7, s[44:47], s48 offen offset:2048 sc0 sc1
    s_waitcnt lgkmcnt(0)
    buffer_store_dwordx4 v[28:31], v7, s[44:47], s48 offen offset:3072 sc0 sc1
    s_endpgm
k1_rfin:
    s_cmp_eq_u32 s50, 0
    s_cbranch_scc1 k1_end
    s_mov_b32 s48, 0x05040100
    s_mov_b32 s49, 0x07060302
    s_waitcnt vmcnt(0)
    s_sub_u32 s53, s3, 8
    s_lshl_b32 s53, s53, 12
    s_add_u32 s53, s53, 149504
    v_and_b32 v8, 7, v0
    v_lshrrev_b32 v9, 3, v0
    v_xor_b32 v10, v8, v9
    v_lshlrev_b32 v10, 4, v10
    v_lshlrev_b32 v9, 2, v9
    ds_bpermute_b32 v48, v9, v12 offset:0
    ds_bpermute_b32 v49, v9, v12 offset:32
    ds_bpermute_b32 v50, v9, v12 offset:64
    ds_bpermute_b32 v51, v9, v12 offset:96
    ds_bpermute_b32 v52, v9, v12 offset:128
    ds_bpermute_b32 v53, v9, v12 offset:160
    ds_bpermute_b32 v54, v9, v12 offset:192
    ds_bpermute_b32 v55, v9, v12 offset:224
    v_and_b32 v11, 31, v0
    v_lshlrev_b32 v11, 7, v11
    v_lshl_add_u32 v11, v8, 4, v11
    v_add_u32 v11, s53, v11
    v_add_u32 v13, s53, v7
    v_perm_b32 v16, v68, v64, s48
    v_perm_b32 v17, v76, v72, s48
    v_perm_b32 v18, v84, v80, s48
    v_perm_b32 v19, v92, v88, s48
    v_xor_b32 v56, 0, v11
    v_perm_b32 v20, v68, v64, s49
    v_perm_b32 v21, v76, v72, s49
    v_perm_b32 v22, v84, v80, s49
    v_perm_b32 v23, v92, v88, s49
    v_xor_b32 v57, 16, v11
    v_perm_b32 v24, v69, v65, s48
    v_perm_b32 v25, v77, v73, s48
    v_perm_b32 v26, v85, v81, s48
    v_perm_b32 v27, v93, v89, s48
    v_xor_b32 v58, 32, v11
    v_perm_b32 v28, v69, v65, s49
    v_perm_b32 v29, v77, v73, s49
    v_perm_b32 v30, v85, v81, s49
    v_perm_b32 v31, v93, v89, s49
    v_xor_b32 v59, 48, v11
    v_perm_b32 v32, v70, v66, s48
    v_perm_b32 v33, v78, v74, s48
    v_perm_b32 v34, v86, v82, s48
    v_perm_b32 v35, v94, v90, s48
    v_xor_b32 v60, 64, v11
    v_perm_b32 v36, v70, v66, s49
    v_perm_b32 v37, v78, v74, s49
    v_perm_b32 v38, v86, v82, s49
    v_perm_b32 v39, v94, v90, s49
    v_xor_b32 v61, 80, v11
    v_perm_b32 v40, v71, v67, s48
    v_perm_b32 v41, v79, v75, s48
    v_perm_b32 v42, v87, v83, s48
    v_perm_b32 v43, v95, v91, s48
    v_xor_b32 v62, 96, v11
    v_perm_b32 v44, v71, v67, s49
    v_perm_b32 v45, v79, v75, s49
    v_perm_b32 v46, v87, v83, s49
    v_perm_b32 v47, v95, v91, s49
    v_xor_b32 v63, 112, v11
    s_waitcnt lgkmcnt(0)
    v_add_u32 v48, v48, v10
    v_add_u32 v49, v49, v10
    v_add_u32 v50, v50, v10
    v_add_u32 v51, v51, v10
    v_add_u32 v52, v52, v10
    v_add_u32 v53, v53, v10
    v_add_u32 v54, v54, v10
    v_add_u32 v55, v55, v10
    s_mov_b32 exec_lo, -1
    s_mov_b32 exec_hi, 0
    ds_write_b128 v56, v[16:19]
    ds_write_b128 v57, v[20:23]
    ds_write_b128 v58, v[24:27]
    ds_write_b128 v59, v[28:31]
    ds_write_b128 v60, v[32:35]
    ds_write_b128 v61, v[36:39]
    ds_write_b128 v62, v[40:43]
    ds_write_b128 v63, v[44:47]
    s_mov_b64 exec, -1
    s_waitcnt lgkmcnt(0)
    ds_read_b128 v[64:67], v13 offset:0
    ds_read_b128 v[68:71], v13 offset:1024
    ds_read_b128 v[72:75], v13 offset:2048
    ds_read_b128 v[76:79], v13 offset:3072
    s_waitcnt lgkmcnt(3)
    buffer_store_dwordx4 v[64:67], v48, s[44:47], s52 offen sc0 sc1
    s_waitcnt lgkmcnt(2)
    buffer_store_dwordx4 v[68:71], v49, s[44:47], s52 offen sc0 sc1
    s_waitcnt lgkmcnt(1)
    buffer_store_dwordx4 v[72:75], v50, s[44:47], s52 offen sc0 sc1
    s_waitcnt lgkmcnt(0)
    buffer_store_dwordx4 v[76:79], v51, s[44:47], s52 offen sc0 sc1
    s_mov_b32 exec_lo, 0
    s_mov_b32 exec_hi, -1
    ds_write_b128 v56, v[16:19]
    ds_write_b128 v57, v[20:23]
    ds_write_b128 v58, v[24:27]
    ds_write_b128 v59, v[28:31]
    ds_write_b128 v60, v[32:35]
    ds_write_b128 v61, v[36:39]
    ds_write_b128 v62, v[40:43]
    ds_write_b128 v63, v[44:47]
    s_mov_b64 exec, -1
    s_waitcnt lgkmcnt(0)
    ds_read_b128 v[80:83], v13 offset:0
    ds_read_b128 v[84:87], v13 offset:1024
    ds_read_b128 v[88:91], v13 offset:2048
    ds_read_b128 v[92:95], v13 offset:3072
    s_waitcnt lgkmcnt(3)
    buffer_store_dwordx4 v[80:83], v52, s[44:47], s52 offen sc0 sc1
    s_waitcnt lgkmcnt(2)
    buffer_store_dwordx4 v[84:87], v53, s[44:47], s52 offen sc0 sc1
    s_waitcnt lgkmcnt(1)
    buffer_store_dwordx4 v[88:91], v54, s[44:47], s52 offen sc0 sc1
    s_waitcnt lgkmcnt(0)
    buffer_store_dwordx4 v[92:95], v55, s[44:47], s52 offen sc0 sc1
    s_waitcnt vmcnt(0)
k1_end:
    s_endpgm
.globl attn_kernel
.p2align 8
.type attn_kernel,@function
attn_kernel:
    s_cmp_ge_u32 s2, 256
    s_cbranch_scc1 k2_end
    s_load_dwordx2 s[22:23], s[0:1], 88
    v_lshrrev_b32 v1, 6, v0
    v_and_b32 v0, 63, v0
    s_nop 0
    v_readfirstlane_b32 s3, v1
    s_lshr_b32 s24, s2, 2
    s_and_b32 s25, s2, 3
    v_lshlrev_b32 v7, 4, v0
    s_waitcnt lgkmcnt(0)
    s_mov_b32 s44, s22
    s_mov_b32 s45, s23
    s_mov_b32 s46, 20971520
    s_mov_b32 s47, 0x00020000
    s_cmp_ge_u32 s3, 8
    s_cbranch_scc1 k2_ffn
    s_lshl_b32 s26, s25, 3
    s_add_u32 s26, s26, s3
    s_lshl_b32 s27, s24, 5
    s_add_u32 s27, s27, s26
    s_lshl_b32 s27, s27, 10
    s_add_u32 s27, s27, 2097152
    buffer_load_dwordx4 v[8:11], v7, s[44:47], s27 offen
    v_lshlrev_b32 v2, 2, v0
    s_mov_b32 s27, 4325376
    buffer_load_dword v3, v2, s[44:47], s27 offen
    s_mul_i32 s28, s3, 3072
    s_mov_b32 m0, s28
    s_add_u32 s29, s28, 4194304
    buffer_load_dwordx4 v7, s[44:47], s29 offen offset:0 lds
    buffer_load_dwordx4 v7, s[44:47], s29 offen offset:1024 lds
    buffer_load_dwordx4 v7, s[44:47], s29 offen offset:2048 lds
    v_and_b32 v4, 27, v0
    v_cmp_eq_u32 vcc, 16, v4
    v_mov_b32 v5, 0x3f803f80
    v_mov_b32 v6, 0
    v_cndmask_b32 v5, v6, v5, vcc
    v_mov_b32 v96, v5
    v_mov_b32 v97, v5
    v_mov_b32 v98, v5
    v_mov_b32 v99, v5
    v_mov_b32 v100, v5
    v_mov_b32 v101, v5
    v_mov_b32 v102, v5
    v_mov_b32 v103, v5
    v_mov_b32 v104, v5
    v_mov_b32 v105, v5
    v_mov_b32 v106, v5
    v_mov_b32 v107, v5
    v_mov_b32 v108, v5
    v_mov_b32 v109, v5
    v_mov_b32 v110, v5
    v_mov_b32 v111, v5
    v_mov_b32 v64, 0
    v_mov_b32 v65, 0
    v_mov_b32 v66, 0
    v_mov_b32 v67, 0
    v_mov_b32 v68, 0
    v_mov_b32 v69, 0
    v_mov_b32 v70, 0
    v_mov_b32 v71, 0
    v_mov_b32 v72, 0
    v_mov_b32 v73, 0
    v_mov_b32 v74, 0
    v_mov_b32 v75, 0
    v_mov_b32 v76, 0
    v_mov_b32 v77, 0
    v_mov_b32 v78, 0
    v_mov_b32 v79, 0
    v_and_b32 v4, 15, v0
    v_lshrrev_b32 v5, 5, v0
    v_lshl_add_u32 v4, v5, 4, v4
    v_lshlrev_b32 v4, 4, v4
    v_add_u32 v4, 1024, v4
    v_mov_b32 v5, v7
    s_mov_b32 s30, 0x0000ffff
    s_mov_b32 s31, 0x0000ffff
    s_waitcnt vmcnt(3)
    v_lshlrev_b32 v13, 16, v8
    v_mul_f32 v12, v13, v13
    v_and_b32 v13, 0xffff0000, v8
    v_fmac_f32 v12, v13, v13
    v_lshlrev_b32 v13, 16, v9
    v_fmac_f32 v12, v13, v13
    v_and_b32 v13, 0xffff0000, v9
    v_fmac_f32 v12, v13, v13
    v_lshlrev_b32 v13, 16, v10
    v_fmac_f32 v12, v13, v13
    v_and_b32 v13, 0xffff0000, v10
    v_fmac_f32 v12, v13, v13
    v_lshlrev_b32 v13, 16, v11
    v_fmac_f32 v12, v13, v13
    v_and_b32 v13, 0xffff0000, v11
    v_fmac_f32 v12, v13, v13
    s_nop 1
    v_mov_b32 v13, v12
    s_nop 1
    v_permlane32_swap_b32 v12, v13
    s_nop 1
    v_add_f32 v12, v12, v13
    s_nop 1
    v_max_f32_dpp v3, v3, v3 quad_perm:[1,0,3,2] row_mask:0xf bank_mask:0xf
    s_nop 1
    v_max_f32_dpp v3, v3, v3 quad_perm:[2,3,0,1] row_mask:0xf bank_mask:0xf
    s_nop 1
    v_mov_b32_dpp v13, v3 row_ror:4 row_mask:0xf bank_mask:0xf
    v_max_f32 v3, v3, v13
    s_nop 1
    v_mov_b32_dpp v13, v3 row_ror:8 row_mask:0xf bank_mask:0xf
    v_max_f32 v3, v3, v13
    s_nop 1
    v_mov_b32 v13, v3
    s_nop 1
    v_permlane16_swap_b32 v3, v13
    s_nop 1
    v_max_f32 v3, v3, v13
    s_nop 1
    v_mov_b32 v13, v3
    s_nop 1
    v_permlane32_swap_b32 v3, v13
    s_nop 1
    v_max_f32 v3, v3, v13
    v_mul_f32 v12, v12, v3
    v_sqrt_f32 v12, v12
    s_nop 0
    v_mul_f32 v12, 0x3f804189, v12
    v_cmp_nge_f32 vcc, 0x42200000, v12
    v_sub_f32 v12, 0, v12
    v_mov_b32 v16, v12
    v_mov_b32 v17, v12
    v_mov_b32 v18, v12
    v_mov_b32 v19, v12
    v_mov_b32 v20, v12
    v_mov_b32 v21, v12
    v_mov_b32 v22, v12
    v_mov_b32 v23, v12
    v_mov_b32 v24, v12
    v_mov_b32 v25, v12
    v_mov_b32 v26, v12
    v_mov_b32 v27, v12
    v_mov_b32 v28, v12
    v_mov_b32 v29, v12
    v_mov_b32 v30, v12
    v_mov_b32 v31, v12
    s_waitcnt vmcnt(0)
    s_barrier
    s_mov_b32 s32, 0x140
    s_cbranch_vccz k2_go
    s_barrier
    s_barrier
    s_mov_b32 s32, 0
    v_mov_b32 v12, 0xff800000
    v_mov_b32 v13, v7
    s_mov_b32 s33, 64
k2_mx:
    ds_read_b128 v[88:91], v13
    v_add_u32 v13, 2048, v13
    s_waitcnt lgkmcnt(0)
    v_mfma_f32_32x32x16_bf16 v[32:47], v[88:91], v[8:11], 0
    s_nop 15
    v_max3_f32 v12, v12, v32, v33
    v_max3_f32 v12, v12, v34, v35
    v_max3_f32 v12, v12, v36, v37
    v_max3_f32 v12, v12, v38, v39
    v_max3_f32 v12, v12, v40, v41
    v_max3_f32 v12, v12, v42, v43
    v_max3_f32 v12, v12, v44, v45
    v_max3_f32 v12, v12, v46, v47
    s_sub_u32 s33, s33, 1
    s_cmp_lg_u32 s33, 0
    s_cbranch_scc1 k2_mx
    s_nop 1
    v_mov_b32 v13, v12
    s_nop 1
    v_permlane32_swap_b32 v12, v13
    s_nop 1
    v_max_f32 v12, v12, v13
    v_sub_f32 v12, 0, v12
    v_mov_b32 v16, v12
    v_mov_b32 v17, v12
    v_mov_b32 v18, v12
    v_mov_b32 v19, v12
    v_mov_b32 v20, v12
    v_mov_b32 v21, v12
    v_mov_b32 v22, v12
    v_mov_b32 v23, v12
    v_mov_b32 v24, v12
    v_mov_b32 v25, v12
    v_mov_b32 v26, v12
    v_mov_b32 v27, v12
    v_mov_b32 v28, v12
    v_mov_b32 v29, v12
    v_mov_b32 v30, v12
    v_mov_b32 v31, v12
k2_go:
    ds_read_b128 v[88:91], v5 offset:0
    ds_read_b128 v[92:95], v5 offset:2048
    s_mov_b64 exec, s[30:31]
    ds_read_b128 v[96:99], v4 offset:0
    ds_read_b128 v[100:103], v4 offset:512
    s_mov_b64 exec, -1
    v_mov_b32 v84, 0
    v_mov_b32 v85, 0
    v_mov_b32 v86, 0
    v_mov_b32 v87, 0
    s_waitcnt lgkmcnt(3)
    v_mfma_f32_32x32x16_bf16 v[32:47], v[88:91], v[8:11], v[16:31]
    s_mov_b32 s33, 8
    s_setprio 1
    s_nop 10
k2_loop:
    v_exp_f32 v32, v32
    v_exp_f32 v33, v33
    v_mfma_f32_32x32x16_bf16 v[64:79], v[108:111], v[84:87], v[64:79]
    v_exp_f32 v34, v34
    v_exp_f32 v35, v35
    v_cvt_pk_bf16_f32 v80, v32, v33
    s_waitcnt lgkmcnt(0)
    v_mfma_f32_32x32x16_bf16 v[48:63], v[92:95], v[8:11], v[16:31]
    ds_read_b128 v[88:91], v5 offset:4096
    s_mov_b64 exec, s[30:31]
    ds_read_b128 v[104:107], v4 offset:2048
    ds_read_b128 v[108:111], v4 offset:2560
    s_mov_b64 exec, -1
    v_exp_f32 v36, v36
    v_exp_f32 v37, v37
    v_cvt_pk_bf16_f32 v81, v34, v35
    v_exp_f32 v38, v38
    v_exp_f32 v39, v39
    v_cvt_pk_bf16_f32 v82, v36, v37
    v_exp_f32 v40, v40
    v_exp_f32 v41, v41
    v_cvt_pk_bf16_f32 v83, v38, v39
    v_exp_f32 v42, v42
    v_exp_f32 v43, v43
    v_cvt_pk_bf16_f32 v84, v40, v41
    v_mfma_f32_32x32x16_bf16 v[64:79], v[96:99], v[80:83], v[64:79]
    v_exp_f32 v44, v44
    v_exp_f32 v45, v45
    v_cvt_pk_bf16_f32 v85, v42, v43
    v_exp_f32 v46, v46
    v_exp_f32 v47, v47
    v_cvt_pk_bf16_f32 v86, v44, v45
    s_nop 0
    v_cvt_pk_bf16_f32 v87, v46, v47
    v_exp_f32 v48, v48
    v_exp_f32 v49, v49
    v_mfma_f32_32x32x16_bf16 v[64:79], v[100:103], v[84:87], v[64:79]
    v_exp_f32 v50, v50
    v_exp_f32 v51, v51
    v_cvt_pk_bf16_f32 v80, v48, v49
    s_waitcnt lgkmcnt(0)
    v_mfma_f32_32x32x16_bf16 v[32:47], v[88:91], v[8:11], v[16:31]
    ds_read_b128 v[92:95], v5 offset:6144
    s_mov_b64 exec, s[30:31]
    ds_read_b128 v[96:99], v4 offset:4096
    ds_read_b128 v[100:103], v4 offset:4608
    s_mov_b64 exec, -1
    v_exp_f32 v52, v52
    v_exp_f32 v53, v53
    v_cvt_pk_bf16_f32 v81, v50, v51
    v_exp_f32 v54, v54
    v_exp_f32 v55, v55
    v_cvt_pk_bf16_f32 v82, v52, v53
    v_exp_f32 v56, v56
    v_exp_f32 v57, v57
    v_cvt_pk_bf16_f32 v83, v54, v55
    v_exp_f32 v58, v58
    v_exp_f32 v59, v59
    v_cvt_pk_bf16_f32 v84, v56, v57
    v_mfma_f32_32x32x16_bf16 v[64:79], v[104:107], v[80:83], v[64:79]
    v_exp_f32 v60, v60
    v_exp_f32 v61, v61
    v_cvt_pk_bf16_f32 v85, v58, v59
    v_exp_f32 v62, v62
    v_exp_f32 v63, v63
    v_cvt_pk_bf16_f32 v86, v60, v61
    s_nop 0
    v_cvt_pk_bf16_f32 v87, v62, v63
    v_exp_f32 v32, v32
    v_exp_f32 v33, v33
    v_mfma_f32_32x32x16_bf16 v[64:79], v[108:111], v[84:87], v[64:79]
    v_exp_f32 v34, v34
    v_exp_f32 v35, v35
    v_cvt_pk_bf16_f32 v80, v32, v33
    s_waitcnt lgkmcnt(0)
    v_mfma_f32_32x32x16_bf16 v[48:63], v[92:95], v[8:11], v[16:31]
    ds_read_b128 v[88:91], v5 offset:8192
    s_mov_b64 exec, s[30:31]
    ds_read_b128 v[104:107], v4 offset:6144
    ds_read_b128 v[108:111], v4 offset:6656
    s_mov_b64 exec, -1
    v_exp_f32 v36, v36
    v_exp_f32 v37, v37
    v_cvt_pk_bf16_f32 v81, v34, v35
    v_exp_f32 v38, v38
    v_exp_f32 v39, v39
    v_cvt_pk_bf16_f32 v82, v36, v37
    v_exp_f32 v40, v40
    v_exp_f32 v41, v41
    v_cvt_pk_bf16_f32 v83, v38, v39
    v_exp_f32 v42, v42
    v_exp_f32 v43, v43
    v_cvt_pk_bf16_f32 v84, v40, v41
    v_mfma_f32_32x32x16_bf16 v[64:79], v[96:99], v[80:83], v[64:79]
    v_exp_f32 v44, v44
    v_exp_f32 v45, v45
    v_cvt_pk_bf16_f32 v85, v42, v43
    v_exp_f32 v46, v46
    v_exp_f32 v47, v47
    v_cvt_pk_bf16_f32 v86, v44, v45
    s_nop 0
    v_cvt_pk_bf16_f32 v87, v46, v47
    v_exp_f32 v48, v48
    v_exp_f32 v49, v49
    v_mfma_f32_32x32x16_bf16 v[64:79], v[100:103], v[84:87], v[64:79]
    v_exp_f32 v50, v50
    v_exp_f32 v51, v51
    v_cvt_pk_bf16_f32 v80, v48, v49
    s_waitcnt lgkmcnt(0)
    v_mfma_f32_32x32x16_bf16 v[32:47], v[88:91], v[8:11], v[16:31]
    ds_read_b128 v[92:95], v5 offset:10240
    s_mov_b64 exec, s[30:31]
    ds_read_b128 v[96:99], v4 offset:8192
    ds_read_b128 v[100:103], v4 offset:8704
    s_mov_b64 exec, -1
    v_exp_f32 v52, v52
    v_exp_f32 v53, v53
    v_cvt_pk_bf16_f32 v81, v50, v51
    v_exp_f32 v54, v54
    v_exp_f32 v55, v55
    v_cvt_pk_bf16_f32 v82, v52, v53
    v_exp_f32 v56, v56
    v_exp_f32 v57, v57
    v_cvt_pk_bf16_f32 v83, v54, v55
    v_exp_f32 v58, v58
    v_exp_f32 v59, v59
    v_cvt_pk_bf16_f32 v84, v56, v57
    v_mfma_f32_32x32x16_bf16 v[64:79], v[104:107], v[80:83], v[64:79]
    v_exp_f32 v60, v60
    v_exp_f32 v61, v61
    v_cvt_pk_bf16_f32 v85, v58, v59
    v_exp_f32 v62, v62
    v_exp_f32 v63, v63
    v_cvt_pk_bf16_f32 v86, v60, v61
    s_nop 0
    v_cvt_pk_bf16_f32 v87, v62, v63
    v_exp_f32 v32, v32
    v_exp_f32 v33, v33
    v_mfma_f32_32x32x16_bf16 v[64:79], v[108:111], v[84:87], v[64:79]
    v_exp_f32 v34, v34
    v_exp_f32 v35, v35
    v_cvt_pk_bf16_f32 v80, v32, v33
    s_waitcnt lgkmcnt(0)
    v_mfma_f32_32x32x16_bf16 v[48:63], v[92:95], v[8:11], v[16:31]
    ds_read_b128 v[88:91], v5 offset:12288
    s_mov_b64 exec, s[30:31]
    ds_read_b128 v[104:107], v4 offset:10240
    ds_read_b128 v[108:111], v4 offset:10752
    s_mov_b64 exec, -1
    v_exp_f32 v36, v36
    v_exp_f32 v37, v37
    v_cvt_pk_bf16_f32 v81, v34, v35
    v_exp_f32 v38, v38
    v_exp_f32 v39, v39
    v_cvt_pk_bf16_f32 v82, v36, v37
    v_exp_f32 v40, v40
    v_exp_f32 v41, v41
    v_cvt_pk_bf16_f32 v83, v38, v39
    v_exp_f32 v42, v42
    v_exp_f32 v43, v43
    v_cvt_pk_bf16_f32 v84, v40, v41
    v_mfma_f32_32x32x16_bf16 v[64:79], v[96:99], v[80:83], v[64:79]
    v_exp_f32 v44, v44
    v_exp_f32 v45, v45
    v_cvt_pk_bf16_f32 v85, v42, v43
    v_exp_f32 v46, v46
    v_exp_f32 v47, v47
    v_cvt_pk_bf16_f32 v86, v44, v45
    s_nop 0
    v_cvt_pk_bf16_f32 v87, v46, v47
    v_exp_f32 v48, v48
    v_exp_f32 v49, v49
    v_mfma_f32_32x32x16_bf16 v[64:79], v[100:103], v[84:87], v[64:79]
    v_exp_f32 v50, v50
    v_exp_f32 v51, v51
    v_cvt_pk_bf16_f32 v80, v48, v49
    s_waitcnt lgkmcnt(0)
    v_mfma_f32_32x32x16_bf16 v[32:47], v[88:91], v[8:11], v[16:31]
    ds_read_b128 v[92:95], v5 offset:14336
    s_mov_b64 exec, s[30:31]
    ds_read_b128 v[96:99], v4 offset:12288
    ds_read_b128 v[100:103], v4 offset:12800
    s_mov_b64 exec, -1
    v_exp_f32 v52, v52
    v_exp_f32 v53, v53
    v_cvt_pk_bf16_f32 v81, v50, v51
    v_exp_f32 v54, v54
    v_exp_f32 v55, v55
    v_cvt_pk_bf16_f32 v82, v52, v53
    v_exp_f32 v56, v56
    v_exp_f32 v57, v57
    v_cvt_pk_bf16_f32 v83, v54, v55
    v_exp_f32 v58, v58
    v_exp_f32 v59, v59
    v_cvt_pk_bf16_f32 v84, v56, v57
    v_mfma_f32_32x32x16_bf16 v[64:79], v[104:107], v[80:83], v[64:79]
    v_exp_f32 v60, v60
    v_exp_f32 v61, v61
    v_cvt_pk_bf16_f32 v85, v58, v59
    v_exp_f32 v62, v62
    v_exp_f32 v63, v63
    v_cvt_pk_bf16_f32 v86, v60, v61
    s_nop 0
    v_cvt_pk_bf16_f32 v87, v62, v63
    v_exp_f32 v32, v32
    v_exp_f32 v33, v33
    v_mfma_f32_32x32x16_bf16 v[64:79], v[108:111], v[84:87], v[64:79]
    v_exp_f32 v34, v34
    v_exp_f32 v35, v35
    v_cvt_pk_bf16_f32 v80, v32, v33
    s_waitcnt lgkmcnt(0)
    v_mfma_f32_32x32x16_bf16 v[48:63], v[92:95], v[8:11], v[16:31]
    ds_read_b128 v[88:91], v5 offset:16384
    s_mov_b64 exec, s[30:31]
    ds_read_b128 v[104:107], v4 offset:14336
    ds_read_b128 v[108:111], v4 offset:14848
    s_mov_b64 exec, -1
    v_exp_f32 v36, v36
    v_exp_f32 v37, v37
    v_cvt_pk_bf16_f32 v81, v34, v35
    v_exp_f32 v38, v38
    v_exp_f32 v39, v39
    v_cvt_pk_bf16_f32 v82, v36, v37
    v_exp_f32 v40, v40
    v_exp_f32 v41, v41
    v_cvt_pk_bf16_f32 v83, v38, v39
    v_exp_f32 v42, v42
    v_exp_f32 v43, v43
    v_cvt_pk_bf16_f32 v84, v40, v41
    v_mfma_f32_32x32x16_bf16 v[64:79], v[96:99], v[80:83], v[64:79]
    v_exp_f32 v44, v44
    v_exp_f32 v45, v45
    v_cvt_pk_bf16_f32 v85, v42, v43
    v_exp_f32 v46, v46
    v_exp_f32 v47, v47
    v_cvt_pk_bf16_f32 v86, v44, v45
    s_nop 0
    v_cvt_pk_bf16_f32 v87, v46, v47
    v_exp_f32 v48, v48
    v_exp_f32 v49, v49
    v_mfma_f32_32x32x16_bf16 v[64:79], v[100:103], v[84:87], v[64:79]
    v_exp_f32 v50, v50
    v_exp_f32 v51, v51
    v_cvt_pk_bf16_f32 v80, v48, v49
    s_waitcnt lgkmcnt(0)
    v_mfma_f32_32x32x16_bf16 v[32:47], v[88:91], v[8:11], v[16:31]
    ds_read_b128 v[92:95], v5 offset:18432
    s_mov_b64 exec, s[30:31]
    ds_read_b128 v[96:99], v4 offset:16384
    ds_read_b128 v[100:103], v4 offset:16896
    s_mov_b64 exec, -1
    v_exp_f32 v52, v52
    v_exp_f32 v53, v53
    v_cvt_pk_bf16_f32 v81, v50, v51
    v_exp_f32 v54, v54
    v_exp_f32 v55, v55
    v_cvt_pk_bf16_f32 v82, v52, v53
    v_exp_f32 v56, v56
    v_exp_f32 v57, v57
    v_cvt_pk_bf16_f32 v83, v54, v55
    v_exp_f32 v58, v58
    v_exp_f32 v59, v59
    v_cvt_pk_bf16_f32 v84, v56, v57
    v_mfma_f32_32x32x16_bf16 v[64:79], v[104:107], v[80:83], v[64:79]
    v_exp_f32 v60, v60
    v_exp_f32 v61, v61
    v_cvt_pk_bf16_f32 v85, v58, v59
    v_exp_f32 v62, v62
    v_exp_f32 v63, v63
    v_cvt_pk_bf16_f32 v86, v60, v61
    v_add_u32 v4, 16384, v4
    v_add_u32 v5, 16384, v5
    v_cvt_pk_bf16_f32 v87, v62, v63
    s_bitcmp1_b32 s32, s33
    s_cbranch_scc0 k2_nb
    s_barrier
k2_nb:
    s_sub_u32 s33, s33, 1
    s_cmp_lg_u32 s33, 0
    s_cbranch_scc1 k2_loop
    v_mfma_f32_32x32x16_bf16 v[64:79], v[108:111], v[84:87], v[64:79]
    s_nop 15
    v_rcp_f32 v12, v72
    s_mul_i32 s27, s24, 118
    s_add_u32 s27, s27, s26
    s_lshl_b32 s27, s27, 10
    s_add_u32 s27, s27, 10485760
    v_mul_f32 v64, v64, v12
    v_mul_f32 v65, v65, v12
    v_mul_f32 v66, v66, v12
    v_mul_f32 v67, v67, v12
    v_mul_f32 v68, v68, v12
    v_mul_f32 v69, v69, v12
    v_mul_f32 v70, v70, v12
    v_mul_f32 v71, v71, v12
    v_cvt_pk_bf16_f32 v80, v64, v65
    v_cvt_pk_bf16_f32 v81, v66, v67
    v_cvt_pk_bf16_f32 v82, v68, v69
    v_cvt_pk_bf16_f32 v83, v70, v71
    buffer_store_dwordx4 v[80:83], v7, s[44:47], s27 offen sc0 sc1
    s_waitcnt lgkmcnt(0)
    s_endpgm
k2_ffn:
    s_sub_u32 s26, s3, 8
    s_lshl_b32 s28, s26, 13
    s_lshl_b32 s29, s24, 15
    s_add_u32 s29, s29, s28
    s_add_u32 s28, s28, 131072
    v_lshlrev_b32 v2, 7, v0
    s_lshr_b32 s38, s24, 1
    s_cmp_eq_u32 s26, 3
    s_cbranch_scc1 k2_pf3
    s_mul_i32 s39, s25, 720896
    s_mul_i32 s38, s38, 22528
    s_add_u32 s39, s39, s38
    s_lshl_b32 s38, s26, 13
    s_add_u32 s39, s39, s38
    s_add_u32 s39, s39, 5242880
    buffer_load_dword v133, v2, s[44:47], s39 offen
    s_branch k2_pfd
k2_pf3:
    s_lshl_b32 s39, s38, 12
    s_add_u32 s39, s39, 4194304
    buffer_load_dword v133, v2, s[44:47], s39 offen
k2_pfd:
    buffer_load_dword v134, v2, s[44:47], s29 offen
    s_barrier
    s_lshl_b32 s38, s26, 10
    s_add_u32 s38, s38, 24576
    s_add_u32 s39, s38, 4194304
    s_mov_b32 m0, s38
    s_add_u32 s38, s38, 4096
    buffer_load_dwordx4 v7, s[44:47], s39 offen lds
    s_add_u32 s39, s39, 4096
    s_mov_b32 m0, s38
    s_add_u32 s38, s38, 4096
    buffer_load_dwordx4 v7, s[44:47], s39 offen lds
    s_add_u32 s39, s39, 4096
    s_mov_b32 m0, s38
    s_add_u32 s38, s38, 4096
    buffer_load_dwordx4 v7, s[44:47], s39 offen lds
    s_add_u32 s39, s39, 4096
    s_mov_b32 m0, s38
    s_add_u32 s38, s38, 4096
    buffer_load_dwordx4 v7, s[44:47], s39 offen lds
    s_add_u32 s39, s39, 4096
    s_mov_b32 m0, s38
    s_add_u32 s38, s38, 4096
    buffer_load_dwordx4 v7, s[44:47], s39 offen lds
    s_add_u32 s39, s39, 4096
    s_mov_b32 m0, s38
    s_add_u32 s38, s38, 4096
    buffer_load_dwordx4 v7, s[44:47], s39 offen lds
    s_add_u32 s39, s39, 4096
    s_mov_b32 m0, s38
    s_add_u32 s38, s38, 4096
    buffer_load_dwordx4 v7, s[44:47], s39 offen lds
    s_add_u32 s39, s39, 4096
    s_mov_b32 m0, s38
    s_add_u32 s38, s38, 4096
    buffer_load_dwordx4 v7, s[44:47], s39 offen lds
    s_add_u32 s39, s39, 4096
    s_mov_b32 m0, s28
    s_add_u32 s28, s28, 4096
    buffer_load_dwordx4 v7, s[44:47], s29 offen offset:0 lds
    buffer_load_dwordx4 v7, s[44:47], s29 offen offset:1024 lds
    buffer_load_dwordx4 v7, s[44:47], s29 offen offset:2048 lds
    buffer_load_dwordx4 v7, s[44:47], s29 offen offset:3072 lds
    s_add_u32 s29, s29, 4096
    s_mov_b32 m0, s28
    s_add_u32 s28, s28, 4096
    buffer_load_dwordx4 v7, s[44:47], s29 offen offset:0 lds
    buffer_load_dwordx4 v7, s[44:47], s29 offen offset:1024 lds
    buffer_load_dwordx4 v7, s[44:47], s29 offen offset:2048 lds
    buffer_load_dwordx4 v7, s[44:47], s29 offen offset:3072 lds
    s_add_u32 s29, s29, 4096
    s_mul_i32 s27, s25, 11
    s_add_u32 s27, s27, s26
    s_lshl_b32 s34, s27, 16
    s_add_u32 s34, s34, 5242880
    buffer_load_dwordx4 v[64:67], v7, s[44:47], s34 offen offset:0
    buffer_load_dwordx4 v[68:71], v7, s[44:47], s34 offen offset:1024
    buffer_load_dwordx4 v[72:75], v7, s[44:47], s34 offen offset:2048
    buffer_load_dwordx4 v[76:79], v7, s[44:47], s34 offen offset:3072
    s_add_u32 s34, s34, 4096
    buffer_load_dwordx4 v[80:83], v7, s[44:47], s34 offen offset:0
    buffer_load_dwordx4 v[84:87], v7, s[44:47], s34 offen offset:1024
    buffer_load_dwordx4 v[88:91], v7, s[44:47], s34 offen offset:2048
    buffer_load_dwordx4 v[92:95], v7, s[44:47], s34 offen offset:3072
    s_add_u32 s34, s34, 4096
    buffer_load_dwordx4 v[96:99], v7, s[44:47], s34 offen offset:0
    buffer_load_dwordx4 v[100:103], v7, s[44:47], s34 offen offset:1024
    buffer_load_dwordx4 v[104:107], v7, s[44:47], s34 offen offset:2048
    buffer_load_dwordx4 v[108:111], v7, s[44:47], s34 offen offset:3072
    s_add_u32 s34, s34, 4096
    buffer_load_dwordx4 v[112:115], v7, s[44:47], s34 offen offset:0
    buffer_load_dwordx4 v[116:119], v7, s[44:47], s34 offen offset:1024
    buffer_load_dwordx4 v[120:123], v7, s[44:47], s34 offen offset:2048
    buffer_load_dwordx4 v[124:127], v7, s[44:47], s34 offen offset:3072
    s_add_u32 s34, s34, 4096
    buffer_load_dword v2, v7, s[44:47], s34 offen
    buffer_load_dword v3, v7, s[44:47], s34 offen
    v_add_u32 v5, 0x20000, v7
    s_mov_b32 s36, 0xc0135761
    v_mov_b32 v6, 0xbdd2d3e8
    s_setprio 1
    s_waitcnt vmcnt(18)
    s_barrier
    s_mov_b32 m0, s38
    s_add_u32 s38, s38, 4096
    buffer_load_dwordx4 v7, s[44:47], s39 offen lds
    s_add_u32 s39, s39, 4096
    s_mov_b32 m0, s38
    s_add_u32 s38, s38, 4096
    buffer_load_dwordx4 v7, s[44:47], s39 offen lds
    s_add_u32 s39, s39, 4096
    s_mov_b32 m0, s38
    s_add_u32 s38, s38, 4096
    buffer_load_dwordx4 v7, s[44:47], s39 offen lds
    s_add_u32 s39, s39, 4096
    s_mov_b32 m0, s38
    s_add_u32 s38, s38, 4096
    buffer_load_dwordx4 v7, s[44:47], s39 offen lds
    s_add_u32 s39, s39, 4096
    s_mov_b32 m0, s38
    s_add_u32 s38, s38, 4096
    buffer_load_dwordx4 v7, s[44:47], s39 offen lds
    s_add_u32 s39, s39, 4096
    s_mov_b32 m0, s38
    s_add_u32 s38, s38, 4096
    buffer_load_dwordx4 v7, s[44:47], s39 offen lds
    s_add_u32 s39, s39, 4096
    s_mov_b32 m0, s38
    s_add_u32 s38, s38, 4096
    buffer_load_dwordx4 v7, s[44:47], s39 offen lds
    s_add_u32 s39, s39, 4096
    s_mov_b32 m0, s38
    s_add_u32 s38, s38, 4096
    buffer_load_dwordx4 v7, s[44:47], s39 offen lds
    s_add_u32 s39, s39, 4096
    s_mov_b32 m0, s38
    s_add_u32 s38, s38, 4096
    buffer_load_dwordx4 v7, s[44:47], s39 offen lds
    s_add_u32 s39, s39, 4096
    s_mov_b32 m0, s38
    s_add_u32 s38, s38, 4096
    buffer_load_dwordx4 v7, s[44:47], s39 offen lds
    s_add_u32 s39, s39, 4096
    s_mov_b32 m0, s38
    s_add_u32 s38, s38, 4096
    buffer_load_dwordx4 v7, s[44:47], s39 offen lds
    s_add_u32 s39, s39, 4096
    s_mov_b32 m0, s38
    s_add_u32 s38, s38, 4096
    buffer_load_dwordx4 v7, s[44:47], s39 offen lds
    s_add_u32 s39, s39, 4096
    s_mov_b32 m0, s38
    s_add_u32 s38, s38, 4096
    buffer_load_dwordx4 v7, s[44:47], s39 offen lds
    s_add_u32 s39, s39, 4096
    s_mov_b32 m0, s38
    s_add_u32 s38, s38, 4096
    buffer_load_dwordx4 v7, s[44:47], s39 offen lds
    s_add_u32 s39, s39, 4096
    s_mov_b32 m0, s38
    s_add_u32 s38, s38, 4096
    buffer_load_dwordx4 v7, s[44:47], s39 offen lds
    s_add_u32 s39, s39, 4096
    s_mov_b32 m0, s38
    s_add_u32 s38, s38, 4096
    buffer_load_dwordx4 v7, s[44:47], s39 offen lds
    s_add_u32 s39, s39, 4096
    s_mov_b32 m0, s38
    s_add_u32 s38, s38, 4096
    buffer_load_dwordx4 v7, s[44:47], s39 offen lds
    s_add_u32 s39, s39, 4096
    s_mov_b32 m0, s38
    s_add_u32 s38, s38, 4096
    buffer_load_dwordx4 v7, s[44:47], s39 offen lds
    s_add_u32 s39, s39, 4096
    s_mov_b32 s32, 0
k2_item:
    ds_read_b128 v[48:51], v5 offset:0
    ds_read_b128 v[52:55], v5 offset:1024
    ds_read_b128 v[56:59], v5 offset:2048
    ds_read_b128 v[60:63], v5 offset:3072
    s_waitcnt vmcnt(16) lgkmcnt(3)
    v_mfma_f32_32x32x16_bf16 v[16:31], v[64:67], v[48:51], 0
    v_mfma_f32_32x32x16_bf16 v[32:47], v[68:71], v[48:51], 0
    buffer_load_dwordx4 v[64:67], v7, s[44:47], s34 offen offset:0
    buffer_load_dwordx4 v[68:71], v7, s[44:47], s34 offen offset:1024
    ds_read_b128 v[48:51], v5 offset:4096
    s_waitcnt vmcnt(16) lgkmcnt(3)
    v_mfma_f32_32x32x16_bf16 v[16:31], v[72:75], v[52:55], v[16:31]
    v_mfma_f32_32x32x16_bf16 v[32:47], v[76:79], v[52:55], v[32:47]
    buffer_load_dwordx4 v[72:75], v7, s[44:47], s34 offen offset:2048
    buffer_load_dwordx4 v[76:79], v7, s[44:47], s34 offen offset:3072
    s_add_u32 s34, s34, 4096
    ds_read_b128 v[52:55], v5 offset:5120
    s_waitcnt vmcnt(16) lgkmcnt(3)
    v_mfma_f32_32x32x16_bf16 v[16:31], v[80:83], v[56:59], v[16:31]
    v_mfma_f32_32x32x16_bf16 v[32:47], v[84:87], v[56:59], v[32:47]
    buffer_load_dwordx4 v[80:83], v7, s[44:47], s34 offen offset:0
    buffer_load_dwordx4 v[84:87], v7, s[44:47], s34 offen offset:1024
    ds_read_b128 v[56:59], v5 offset:6144
    s_waitcnt vmcnt(16) lgkmcnt(3)
    v_mfma_f32_32x32x16_bf16 v[16:31], v[88:91], v[60:63], v[16:31]
    v_mfma_f32_32x32x16_bf16 v[32:47], v[92:95], v[60:63], v[32:47]
    buffer_load_dwordx4 v[88:91], v7, s[44:47], s34 offen offset:2048
    buffer_load_dwordx4 v[92:95], v7, s[44:47], s34 offen offset:3072
    s_add_u32 s34, s34, 4096
    ds_read_b128 v[60:63], v5 offset:7168
    s_waitcnt vmcnt(16) lgkmcnt(3)
    v_mfma_f32_32x32x16_bf16 v[16:31], v[96:99], v[48:51], v[16:31]
    v_mfma_f32_32x32x16_bf16 v[32:47], v[100:103], v[48:51], v[32:47]
    buffer_load_dwordx4 v[96:99], v7, s[44:47], s34 offen offset:0
    buffer_load_dwordx4 v[100:103], v7, s[44:47], s34 offen offset:1024
    ds_read_b128 v[48:51], v5 offset:8192
    s_waitcnt vmcnt(16) lgkmcnt(3)
    v_mfma_f32_32x32x16_bf16 v[16:31], v[104:107], v[52:55], v[16:31]
    v_mfma_f32_32x32x16_bf16 v[32:47], v[108:111], v[52:55], v[32:47]
    buffer_load_dwordx4 v[104:107], v7, s[44:47], s34 offen offset:2048
    buffer_load_dwordx4 v[108:111], v7, s[44:47], s34 offen offset:3072
    s_add_u32 s34, s34, 4096
    ds_read_b128 v[52:55], v5 offset:9216
    s_waitcnt vmcnt(16) lgkmcnt(3)
    v_mfma_f32_32x32x16_bf16 v[16:31], v[112:115], v[56:59], v[16:31]
    v_mfma_f32_32x32x16_bf16 v[32:47], v[116:119], v[56:59], v[32:47]
    buffer_load_dwordx4 v[112:115], v7, s[44:47], s34 offen offset:0
    buffer_load_dwordx4 v[116:119], v7, s[44:47], s34 offen offset:1024
    ds_read_b128 v[56:59], v5 offset:10240
    s_waitcnt vmcnt(16) lgkmcnt(3)
    v_mfma_f32_32x32x16_bf16 v[16:31], v[120:123], v[60:63], v[16:31]
    v_mfma_f32_32x32x16_bf16 v[32:47], v[124:127], v[60:63], v[32:47]
    buffer_load_dwordx4 v[120:123], v7, s[44:47], s34 offen offset:2048
    buffer_load_dwordx4 v[124:127], v7, s[44:47], s34 offen offset:3072
    s_add_u32 s34, s34, 4096
    ds_read_b128 v[60:63], v5 offset:11264
    s_waitcnt vmcnt(14) lgkmcnt(3)
    v_mfma_f32_32x32x16_bf16 v[16:31], v[64:67], v[48:51], v[16:31]
    v_mfma_f32_32x32x16_bf16 v[32:47], v[68:71], v[48:51], v[32:47]
    buffer_load_dwordx4 v[64:67], v7, s[44:47], s34 offen offset:0
    buffer_load_dwordx4 v[68:71], v7, s[44:47], s34 offen offset:1024
    ds_read_b128 v[48:51], v5 offset:12288
    s_waitcnt vmcnt(14) lgkmcnt(3)
    v_mfma_f32_32x32x16_bf16 v[16:31], v[72:75], v[52:55], v[16:31]
    v_mfma_f32_32x32x16_bf16 v[32:47], v[76:79], v[52:55], v[32:47]
    buffer_load_dwordx4 v[72:75], v7, s[44:47], s34 offen offset:2048
    buffer_load_dwordx4 v[76:79], v7, s[44:47], s34 offen offset:3072
    s_add_u32 s34, s34, 4096
    ds_read_b128 v[52:55], v5 offset:13312
    s_waitcnt vmcnt(14) lgkmcnt(3)
    v_mfma_f32_32x32x16_bf16 v[16:31], v[80:83], v[56:59], v[16:31]
    v_mfma_f32_32x32x16_bf16 v[32:47], v[84:87], v[56:59], v[32:47]
    buffer_load_dwordx4 v[80:83], v7, s[44:47], s34 offen offset:0
    buffer_load_dwordx4 v[84:87], v7, s[44:47], s34 offen offset:1024
    ds_read_b128 v[56:59], v5 offset:14336
    s_waitcnt vmcnt(14) lgkmcnt(3)
    v_mfma_f32_32x32x16_bf16 v[16:31], v[88:91], v[60:63], v[16:31]
    v_mfma_f32_32x32x16_bf16 v[32:47], v[92:95], v[60:63], v[32:47]
    buffer_load_dwordx4 v[88:91], v7, s[44:47], s34 offen offset:2048
    buffer_load_dwordx4 v[92:95], v7, s[44:47], s34 offen offset:3072
    s_add_u32 s34, s34, 4096
    ds_read_b128 v[60:63], v5 offset:15360
    s_waitcnt vmcnt(14) lgkmcnt(3)
    v_mfma_f32_32x32x16_bf16 v[16:31], v[96:99], v[48:51], v[16:31]
    v_mfma_f32_32x32x16_bf16 v[32:47], v[100:103], v[48:51], v[32:47]
    buffer_load_dwordx4 v[96:99], v7, s[44:47], s34 offen offset:0
    buffer_load_dwordx4 v[100:103], v7, s[44:47], s34 offen offset:1024
    ds_read_b128 v[48:51], v5 offset:16384
    s_waitcnt vmcnt(14) lgkmcnt(3)
    v_mfma_f32_32x32x16_bf16 v[16:31], v[104:107], v[52:55], v[16:31]
    v_mfma_f32_32x32x16_bf16 v[32:47], v[108:111], v[52:55], v[32:47]
    buffer_load_dwordx4 v[104:107], v7, s[44:47], s34 offen offset:2048
    buffer_load_dwordx4 v[108:111], v7, s[44:47], s34 offen offset:3072
    s_add_u32 s34, s34, 4096
    ds_read_b128 v[52:55], v5 offset:17408
    s_waitcnt vmcnt(14) lgkmcnt(3)
    v_mfma_f32_32x32x16_bf16 v[16:31], v[112:115], v[56:59], v[16:31]
    v_mfma_f32_32x32x16_bf16 v[32:47], v[116:119], v[56:59], v[32:47]
    buffer_load_dwordx4 v[112:115], v7, s[44:47], s34 offen offset:0
    buffer_load_dwordx4 v[116:119], v7, s[44:47], s34 offen offset:1024
    ds_read_b128 v[56:59], v5 offset:18432
    s_waitcnt vmcnt(14) lgkmcnt(3)
    v_mfma_f32_32x32x16_bf16 v[16:31], v[120:123], v[60:63], v[16:31]
    v_mfma_f32_32x32x16_bf16 v[32:47], v[124:127], v[60:63], v[32:47]
    buffer_load_dwordx4 v[120:123], v7, s[44:47], s34 offen offset:2048
    buffer_load_dwordx4 v[124:127], v7, s[44:47], s34 offen offset:3072
    s_add_u32 s34, s34, 4096
    ds_read_b128 v[60:63], v5 offset:19456
    s_waitcnt vmcnt(14) lgkmcnt(3)
    v_mfma_f32_32x32x16_bf16 v[16:31], v[64:67], v[48:51], v[16:31]
    v_mfma_f32_32x32x16_bf16 v[32:47], v[68:71], v[48:51], v[32:47]
    buffer_load_dwordx4 v[64:67], v7, s[44:47], s34 offen offset:0
    buffer_load_dwordx4 v[68:71], v7, s[44:47], s34 offen offset:1024
    ds_read_b128 v[48:51], v5 offset:20480
    s_waitcnt vmcnt(14) lgkmcnt(3)
    v_mfma_f32_32x32x16_bf16 v[16:31], v[72:75], v[52:55], v[16:31]
    v_mfma_f32_32x32x16_bf16 v[32:47], v[76:79], v[52:55], v[32:47]
    buffer_load_dwordx4 v[72:75], v7, s[44:47], s34 offen offset:2048
    buffer_load_dwordx4 v[76:79], v7, s[44:47], s34 offen offset:3072
    s_add_u32 s34, s34, 4096
    ds_read_b128 v[52:55], v5 offset:21504
    s_waitcnt vmcnt(14) lgkmcnt(3)
    v_mfma_f32_32x32x16_bf16 v[16:31], v[80:83], v[56:59], v[16:31]
    v_mfma_f32_32x32x16_bf16 v[32:47], v[84:87], v[56:59], v[32:47]
    buffer_load_dwordx4 v[80:83], v7, s[44:47], s34 offen offset:0
    buffer_load_dwordx4 v[84:87], v7, s[44:47], s34 offen offset:1024
    ds_read_b128 v[56:59], v5 offset:22528
    s_waitcnt vmcnt(14) lgkmcnt(3)
    v_mfma_f32_32x32x16_bf16 v[16:31], v[88:91], v[60:63], v[16:31]
    v_mfma_f32_32x32x16_bf16 v[32:47], v[92:95], v[60:63], v[32:47]
    buffer_load_dwordx4 v[88:91], v7, s[44:47], s34 offen offset:2048
    buffer_load_dwordx4 v[92:95], v7, s[44:47], s34 offen offset:3072
    s_add_u32 s34, s34, 4096
    ds_read_b128 v[60:63], v5 offset:23552
    s_waitcnt vmcnt(14) lgkmcnt(3)
    v_mfma_f32_32x32x16_bf16 v[16:31], v[96:99], v[48:51], v[16:31]
    v_mfma_f32_32x32x16_bf16 v[32:47], v[100:103], v[48:51], v[32:47]
    buffer_load_dwordx4 v[96:99], v7, s[44:47], s34 offen offset:0
    buffer_load_dwordx4 v[100:103], v7, s[44:47], s34 offen offset:1024
    ds_read_b128 v[48:51], v5 offset:24576
    s_waitcnt vmcnt(14) lgkmcnt(3)
    v_mfma_f32_32x32x16_bf16 v[16:31], v[104:107], v[52:55], v[16:31]
    v_mfma_f32_32x32x16_bf16 v[32:47], v[108:111], v[52:55], v[32:47]
    buffer_load_dwordx4 v[104:107], v7, s[44:47], s34 offen offset:2048
    buffer_load_dwordx4 v[108:111], v7, s[44:47], s34 offen offset:3072
    s_add_u32 s34, s34, 4096
    ds_read_b128 v[52:55], v5 offset:25600
    s_waitcnt vmcnt(14) lgkmcnt(3)
    v_mfma_f32_32x32x16_bf16 v[16:31], v[112:115], v[56:59], v[16:31]
    v_mfma_f32_32x32x16_bf16 v[32:47], v[116:119], v[56:59], v[32:47]
    buffer_load_dwordx4 v[112:115], v7, s[44:47], s34 offen offset:0
    buffer_load_dwordx4 v[116:119], v7, s[44:47], s34 offen offset:1024
    ds_read_b128 v[56:59], v5 offset:26624
    s_waitcnt vmcnt(14) lgkmcnt(3)
    v_mfma_f32_32x32x16_bf16 v[16:31], v[120:123], v[60:63], v[16:31]
    v_mfma_f32_32x32x16_bf16 v[32:47], v[124:127], v[60:63], v[32:47]
    buffer_load_dwordx4 v[120:123], v7, s[44:47], s34 offen offset:2048
    buffer_load_dwordx4 v[124:127], v7, s[44:47], s34 offen offset:3072
    s_add_u32 s34, s34, 200704
    ds_read_b128 v[60:63], v5 offset:27648
    s_waitcnt vmcnt(14) lgkmcnt(3)
    v_mfma_f32_32x32x16_bf16 v[16:31], v[64:67], v[48:51], v[16:31]
    v_mfma_f32_32x32x16_bf16 v[32:47], v[68:71], v[48:51], v[32:47]
    buffer_load_dwordx4 v[64:67], v7, s[44:47], s34 offen offset:0
    buffer_load_dwordx4 v[68:71], v7, s[44:47], s34 offen offset:1024
    ds_read_b128 v[48:51], v5 offset:28672
    s_waitcnt vmcnt(14) lgkmcnt(3)
    v_mfma_f32_32x32x16_bf16 v[16:31], v[72:75], v[52:55], v[16:31]
    v_mfma_f32_32x32x16_bf16 v[32:47], v[76:79], v[52:55], v[32:47]
    buffer_load_dwordx4 v[72:75], v7, s[44:47], s34 offen offset:2048
    buffer_load_dwordx4 v[76:79], v7, s[44:47], s34 offen offset:3072
    s_add_u32 s34, s34, 4096
    ds_read_b128 v[52:55], v5 offset:29696
    s_waitcnt vmcnt(14) lgkmcnt(3)
    v_mfma_f32_32x32x16_bf16 v[16:31], v[80:83], v[56:59], v[16:31]
    v_mfma_f32_32x32x16_bf16 v[32:47], v[84:87], v[56:59], v[32:47]
    buffer_load_dwordx4 v[80:83], v7, s[44:47], s34 offen offset:0
    buffer_load_dwordx4 v[84:87], v7, s[44:47], s34 offen offset:1024
    ds_read_b128 v[56:59], v5 offset:30720
    s_waitcnt vmcnt(14) lgkmcnt(3)
    v_mfma_f32_32x32x16_bf16 v[16:31], v[88:91], v[60:63], v[16:31]
    v_mfma_f32_32x32x16_bf16 v[32:47], v[92:95], v[60:63], v[32:47]
    buffer_load_dwordx4 v[88:91], v7, s[44:47], s34 offen offset:2048
    buffer_load_dwordx4 v[92:95], v7, s[44:47], s34 offen offset:3072
    s_add_u32 s34, s34, 4096
    ds_read_b128 v[60:63], v5 offset:31744
    s_waitcnt vmcnt(14) lgkmcnt(3)
    v_mfma_f32_32x32x16_bf16 v[16:31], v[96:99], v[48:51], v[16:31]
    v_mfma_f32_32x32x16_bf16 v[32:47], v[100:103], v[48:51], v[32:47]
    buffer_load_dwordx4 v[96:99], v7, s[44:47], s34 offen offset:0
    buffer_load_dwordx4 v[100:103], v7, s[44:47], s34 offen offset:1024
    s_waitcnt vmcnt(14) lgkmcnt(2)
    v_mfma_f32_32x32x16_bf16 v[16:31], v[104:107], v[52:55], v[16:31]
    v_mfma_f32_32x32x16_bf16 v[32:47], v[108:111], v[52:55], v[32:47]
    buffer_load_dwordx4 v[104:107], v7, s[44:47], s34 offen offset:2048
    buffer_load_dwordx4 v[108:111], v7, s[44:47], s34 offen offset:3072
    s_add_u32 s34, s34, 4096
    s_waitcnt vmcnt(14) lgkmcnt(1)
    v_mfma_f32_32x32x16_bf16 v[16:31], v[112:115], v[56:59], v[16:31]
    v_mfma_f32_32x32x16_bf16 v[32:47], v[116:119], v[56:59], v[32:47]
    buffer_load_dwordx4 v[112:115], v7, s[44:47], s34 offen offset:0
    buffer_load_dwordx4 v[116:119], v7, s[44:47], s34 offen offset:1024
    s_waitcnt vmcnt(14) lgkmcnt(0)
    v_mfma_f32_32x32x16_bf16 v[16:31], v[120:123], v[60:63], v[16:31]
    v_mfma_f32_32x32x16_bf16 v[32:47], v[124:127], v[60:63], v[32:47]
    buffer_load_dwordx4 v[120:123], v7, s[44:47], s34 offen offset:2048
    buffer_load_dwordx4 v[124:127], v7, s[44:47], s34 offen offset:3072
    s_add_u32 s34, s34, 4096
    s_mul_i32 s35, s24, 118
    s_lshl_b32 s37, s27, 1
    s_add_u32 s35, s35, s37
    s_add_u32 s35, s35, 32
    s_lshl_b32 s35, s35, 10
    s_add_u32 s35, s35, 10485760
    s_nop 8
    v_mul_f32 v128, v16, v16
    v_mul_f32 v129, v17, v17
    v_mul_f32 v130, v18, v18
    v_mul_f32 v131, v19, v19
    v_fma_f32 v128, v128, v6, s36
    v_fma_f32 v129, v129, v6, s36
    v_fma_f32 v130, v130, v6, s36
    v_fma_f32 v131, v131, v6, s36
    v_mul_f32 v128, v128, v16
    v_mul_f32 v129, v129, v17
    v_mul_f32 v130, v130, v18
    v_mul_f32 v131, v131, v19
    v_exp_f32 v128, v128
    v_mul_f32 v16, v16, v32
    v_exp_f32 v129, v129
    v_mul_f32 v17, v17, v33
    v_exp_f32 v130, v130
    v_mul_f32 v18, v18, v34
    v_exp_f32 v131, v131
    v_mul_f32 v19, v19, v35
    v_add_f32 v128, 1.0, v128
    v_add_f32 v129, 1.0, v129
    v_add_f32 v130, 1.0, v130
    v_add_f32 v131, 1.0, v131
    v_rcp_f32 v128, v128
    v_rcp_f32 v129, v129
    v_rcp_f32 v130, v130
    v_rcp_f32 v131, v131
    s_nop 0
    v_mul_f32 v16, v16, v128
    v_mul_f32 v17, v17, v129
    v_mul_f32 v18, v18, v130
    v_mul_f32 v19, v19, v131
    v_cvt_pk_bf16_f32 v8, v16, v17
    v_cvt_pk_bf16_f32 v9, v18, v19
    v_mul_f32 v128, v20, v20
    v_mul_f32 v129, v21, v21
    v_mul_f32 v130, v22, v22
    v_mul_f32 v131, v23, v23
    v_fma_f32 v128, v128, v6, s36
    v_fma_f32 v129, v129, v6, s36
    v_fma_f32 v130, v130, v6, s36
    v_fma_f32 v131, v131, v6, s36
    v_mul_f32 v128, v128, v20
    v_mul_f32 v129, v129, v21
    v_mul_f32 v130, v130, v22
    v_mul_f32 v131, v131, v23
    v_exp_f32 v128, v128
    v_mul_f32 v20, v20, v36
    v_exp_f32 v129, v129
    v_mul_f32 v21, v21, v37
    v_exp_f32 v130, v130
    v_mul_f32 v22, v22, v38
    v_exp_f32 v131, v131
    v_mul_f32 v23, v23, v39
    v_add_f32 v128, 1.0, v128
    v_add_f32 v129, 1.0, v129
    v_add_f32 v130, 1.0, v130
    v_add_f32 v131, 1.0, v131
    v_rcp_f32 v128, v128
    v_rcp_f32 v129, v129
    v_rcp_f32 v130, v130
    v_rcp_f32 v131, v131
    s_nop 0
    v_mul_f32 v20, v20, v128
    v_mul_f32 v21, v21, v129
    v_mul_f32 v22, v22, v130
    v_mul_f32 v23, v23, v131
    v_cvt_pk_bf16_f32 v10, v20, v21
    v_cvt_pk_bf16_f32 v11, v22, v23
    v_mul_f32 v128, v24, v24
    v_mul_f32 v129, v25, v25
    v_mul_f32 v130, v26, v26
    v_mul_f32 v131, v27, v27
    v_fma_f32 v128, v128, v6, s36
    v_fma_f32 v129, v129, v6, s36
    v_fma_f32 v130, v130, v6, s36
    v_fma_f32 v131, v131, v6, s36
    v_mul_f32 v128, v128, v24
    v_mul_f32 v129, v129, v25
    v_mul_f32 v130, v130, v26
    v_mul_f32 v131, v131, v27
    v_exp_f32 v128, v128
    v_mul_f32 v24, v24, v40
    v_exp_f32 v129, v129
    v_mul_f32 v25, v25, v41
    v_exp_f32 v130, v130
    v_mul_f32 v26, v26, v42
    v_exp_f32 v131, v131
    v_mul_f32 v27, v27, v43
    v_add_f32 v128, 1.0, v128
    v_add_f32 v129, 1.0, v129
    v_add_f32 v130, 1.0, v130
    v_add_f32 v131, 1.0, v131
    v_rcp_f32 v128, v128
    v_rcp_f32 v129, v129
    v_rcp_f32 v130, v130
    v_rcp_f32 v131, v131
    s_nop 0
    v_mul_f32 v24, v24, v128
    v_mul_f32 v25, v25, v129
    v_mul_f32 v26, v26, v130
    v_mul_f32 v27, v27, v131
    v_cvt_pk_bf16_f32 v12, v24, v25
    v_cvt_pk_bf16_f32 v13, v26, v27
    v_mul_f32 v128, v28, v28
    v_mul_f32 v129, v29, v29
    v_mul_f32 v130, v30, v30
    v_mul_f32 v131, v31, v31
    v_fma_f32 v128, v128, v6, s36
    v_fma_f32 v129, v129, v6, s36
    v_fma_f32 v130, v130, v6, s36
    v_fma_f32 v131, v131, v6, s36
    v_mul_f32 v128, v128, v28
    v_mul_f32 v129, v129, v29
    v_mul_f32 v130, v130, v30
    v_mul_f32 v131, v131, v31
    v_exp_f32 v128, v128
    v_mul_f32 v28, v28, v44
    v_exp_f32 v129, v129
    v_mul_f32 v29, v29, v45
    v_exp_f32 v130, v130
    v_mul_f32 v30, v30, v46
    v_exp_f32 v131, v131
    v_mul_f32 v31, v31, v47
    v_add_f32 v128, 1.0, v128
    v_add_f32 v129, 1.0, v129
    v_add_f32 v130, 1.0, v130
    v_add_f32 v131, 1.0, v131
    v_rcp_f32 v128, v128
    v_rcp_f32 v129, v129
    v_rcp_f32 v130, v130
    v_rcp_f32 v131, v131
    s_nop 0
    v_mul_f32 v28, v28, v128
    v_mul_f32 v29, v29, v129
    v_mul_f32 v30, v30, v130
    v_mul_f32 v31, v31, v131
    v_cvt_pk_bf16_f32 v14, v28, v29
    v_cvt_pk_bf16_f32 v15, v30, v31
    buffer_store_dwordx4 v[8:11], v7, s[44:47], s35 offen sc0 sc1
    buffer_store_dwordx4 v[12:15], v7, s[44:47], s35 offen offset:1024 sc0 sc1
    s_cmp_lg_u32 s32, 0
    s_cbranch_scc1 k2_fnb
    s_barrier
    s_mov_b32 s32, 1
k2_fnb:
    s_add_u32 s26, s26, 4
    s_add_u32 s27, s27, 4
    s_cmp_ge_u32 s26, 11
    s_cbranch_scc1 k2_fend
    s_cmp_lt_u32 s27, 43
    s_cbranch_scc1 k2_item
k2_fend:
    s_waitcnt vmcnt(0)
k2_end:
    s_endpgm
.globl outp_kernel
.p2align 8
.type outp_kernel,@function
outp_kernel:
    s_cmp_ge_u32 s2, 256
    s_cbranch_scc1 k3_end
    s_load_dwordx2 s[4:5], s[0:1], 0
    s_load_dwordx2 s[6:7], s[0:1], 72
    s_load_dwordx2 s[22:23], s[0:1], 88
    v_lshrrev_b32 v1, 6, v0
    v_and_b32 v0, 63, v0
    s_nop 0
    v_readfirstlane_b32 s3, v1
    s_and_b32 s24, s2, 7
    s_lshl_b32 s24, s24, 2
    s_bfe_u32 s25, s2, 0x20003
    s_add_u32 s24, s24, s25
    s_lshr_b32 s25, s2, 5
    v_lshlrev_b32 v7, 4, v0
    v_add_u32 v6, 120832, v7
    s_mul_i32 s26, s25, 241664
    s_lshl_b32 s28, s3, 10
    s_add_u32 s26, s26, s28
    s_add_u32 s26, s26, 8388608
    s_mul_i32 s27, s24, 241664
    s_add_u32 s27, s27, s28
    s_add_u32 s27, s27, 10485760
    s_waitcnt lgkmcnt(0)
    s_mov_b32 s44, s22
    s_mov_b32 s45, s23
    s_mov_b32 s46, 20971520
    s_mov_b32 s47, 0x00020000
    s_mov_b32 s28, s4
    s_mov_b32 s29, s5
    s_mov_b32 s30, 2097152
    s_mov_b32 s31, 0x00020000
    s_mov_b32 s32, s6
    s_mov_b32 s33, s7
    s_mov_b32 s34, 2097152
    s_mov_b32 s35, 0x00020000
    s_lshl_b32 s36, s24, 1
    s_lshr_b32 s37, s3, 1
    s_add_u32 s36, s36, s37
    s_lshl_b32 s36, s36, 15
    s_lshl_b32 s37, s25, 1
    s_and_b32 s38, s3, 1
    s_add_u32 s37, s37, s38
    s_lshl_b32 s37, s37, 6
    s_add_u32 s36, s36, s37
    v_and_b32 v2, 31, v0
    v_lshrrev_b32 v3, 5, v0
    v_lshlrev_b32 v2, 10, v2
    v_lshl_add_u32 v2, v3, 3, v2
    buffer_load_dwordx4 v[80:83], v7, s[44:47], s26 offen
    buffer_load_dwordx4 v[88:91], v7, s[44:47], s27 offen
    buffer_load_dwordx4 v[84:87], v6, s[44:47], s26 offen
    buffer_load_dwordx4 v[92:95], v6, s[44:47], s27 offen
    s_add_u32 s26, s26, 4096
    s_add_u32 s27, s27, 4096
    buffer_load_dwordx4 v[96:99], v7, s[44:47], s26 offen
    buffer_load_dwordx4 v[104:107], v7, s[44:47], s27 offen
    buffer_load_dwordx4 v[100:103], v6, s[44:47], s26 offen
    buffer_load_dwordx4 v[108:111], v6, s[44:47], s27 offen
    s_add_u32 s26, s26, 4096
    s_add_u32 s27, s27, 4096
    buffer_load_dwordx4 v[112:115], v7, s[44:47], s26 offen
    buffer_load_dwordx4 v[120:123], v7, s[44:47], s27 offen
    buffer_load_dwordx4 v[116:119], v6, s[44:47], s26 offen
    buffer_load_dwordx4 v[124:127], v6, s[44:47], s27 offen
    s_add_u32 s26, s26, 4096
    s_add_u32 s27, s27, 4096
    buffer_load_dwordx4 v[128:131], v7, s[44:47], s26 offen
    buffer_load_dwordx4 v[136:139], v7, s[44:47], s27 offen
    buffer_load_dwordx4 v[132:135], v6, s[44:47], s26 offen
    buffer_load_dwordx4 v[140:143], v6, s[44:47], s27 offen
    s_add_u32 s26, s26, 4096
    s_add_u32 s27, s27, 4096
    buffer_load_dwordx4 v[144:147], v7, s[44:47], s26 offen
    buffer_load_dwordx4 v[152:155], v7, s[44:47], s27 offen
    buffer_load_dwordx4 v[148:151], v6, s[44:47], s26 offen
    buffer_load_dwordx4 v[156:159], v6, s[44:47], s27 offen
    s_add_u32 s26, s26, 4096
    s_add_u32 s27, s27, 4096
    buffer_load_dwordx4 v[160:163], v7, s[44:47], s26 offen
    buffer_load_dwordx4 v[168:171], v7, s[44:47], s27 offen
    buffer_load_dwordx4 v[164:167], v6, s[44:47], s26 offen
    buffer_load_dwordx4 v[172:175], v6, s[44:47], s27 offen
    s_add_u32 s26, s26, 4096
    s_add_u32 s27, s27, 4096
    buffer_load_dwordx4 v[176:179], v7, s[44:47], s26 offen
    buffer_load_dwordx4 v[184:187], v7, s[44:47], s27 offen
    buffer_load_dwordx4 v[180:183], v6, s[44:47], s26 offen
    buffer_load_dwordx4 v[188:191], v6, s[44:47], s27 offen
    s_add_u32 s26, s26, 4096
    s_add_u32 s27, s27, 4096
    s_waitcnt vmcnt(24)
    v_mfma_f32_32x32x16_bf16 v[16:31], v[80:83], v[88:91], 0
    v_mfma_f32_32x32x16_bf16 v[32:47], v[84:87], v[88:91], 0
    v_mfma_f32_32x32x16_bf16 v[48:63], v[80:83], v[92:95], 0
    v_mfma_f32_32x32x16_bf16 v[64:79], v[84:87], v[92:95], 0
    buffer_load_dwordx4 v[80:83], v7, s[44:47], s26 offen
    buffer_load_dwordx4 v[88:91], v7, s[44:47], s27 offen
    buffer_load_dwordx4 v[84:87], v6, s[44:47], s26 offen
    buffer_load_dwordx4 v[92:95], v6, s[44:47], s27 offen
    s_add_u32 s26, s26, 4096
    s_add_u32 s27, s27, 4096
    s_waitcnt vmcnt(24)
    v_mfma_f32_32x32x16_bf16 v[16:31], v[96:99], v[104:107], v[16:31]
    v_mfma_f32_32x32x16_bf16 v[32:47], v[100:103], v[104:107], v[32:47]
    v_mfma_f32_32x32x16_bf16 v[48:63], v[96:99], v[108:111], v[48:63]
    v_mfma_f32_32x32x16_bf16 v[64:79], v[100:103], v[108:111], v[64:79]
    buffer_load_dwordx4 v[96:99], v7, s[44:47], s26 offen
    buffer_load_dwordx4 v[104:107], v7, s[44:47], s27 offen
    buffer_load_dwordx4 v[100:103], v6, s[44:47], s26 offen
    buffer_load_dwordx4 v[108:111], v6, s[44:47], s27 offen
    s_add_u32 s26, s26, 4096
    s_add_u32 s27, s27, 4096
    s_waitcnt vmcnt(24)
    v_mfma_f32_32x32x16_bf16 v[16:31], v[112:115], v[120:123], v[16:31]
    v_mfma_f32_32x32x16_bf16 v[32:47], v[116:119], v[120:123], v[32:47]
    v_mfma_f32_32x32x16_bf16 v[48:63], v[112:115], v[124:127], v[48:63]
    v_mfma_f32_32x32x16_bf16 v[64:79], v[116:119], v[124:127], v[64:79]
    buffer_load_dwordx4 v[112:115], v7, s[44:47], s26 offen
    buffer_load_dwordx4 v[120:123], v7, s[44:47], s27 offen
    buffer_load_dwordx4 v[116:119], v6, s[44:47], s26 offen
    buffer_load_dwordx4 v[124:127], v6, s[44:47], s27 offen
    s_add_u32 s26, s26, 4096
    s_add_u32 s27, s27, 4096
    s_waitcnt vmcnt(24)
    v_mfma_f32_32x32x16_bf16 v[16:31], v[128:131], v[136:139], v[16:31]
    v_mfma_f32_32x32x16_bf16 v[32:47], v[132:135], v[136:139], v[32:47]
    v_mfma_f32_32x32x16_bf16 v[48:63], v[128:131], v[140:143], v[48:63]
    v_mfma_f32_32x32x16_bf16 v[64:79], v[132:135], v[140:143], v[64:79]
    buffer_load_dwordx4 v[128:131], v7, s[44:47], s26 offen
    buffer_load_dwordx4 v[136:139], v7, s[44:47], s27 offen
    buffer_load_dwordx4 v[132:135], v6, s[44:47], s26 offen
    buffer_load_dwordx4 v[140:143], v6, s[44:47], s27 offen
    s_add_u32 s26, s26, 4096
    s_add_u32 s27, s27, 4096
    s_waitcnt vmcnt(24)
    v_mfma_f32_32x32x16_bf16 v[16:31], v[144:147], v[152:155], v[16:31]
    v_mfma_f32_32x32x16_bf16 v[32:47], v[148:151], v[152:155], v[32:47]
    v_mfma_f32_32x32x16_bf16 v[48:63], v[144:147], v[156:159], v[48:63]
    v_mfma_f32_32x32x16_bf16 v[64:79], v[148:151], v[156:159], v[64:79]
    buffer_load_dwordx4 v[144:147], v7, s[44:47], s26 offen
    buffer_load_dwordx4 v[152:155], v7, s[44:47], s27 offen
    buffer_load_dwordx4 v[148:151], v6, s[44:47], s26 offen
    buffer_load_dwordx4 v[156:159], v6, s[44:47], s27 offen
    s_add_u32 s26, s26, 4096
    s_add_u32 s27, s27, 4096
    s_waitcnt vmcnt(24)
    v_mfma_f32_32x32x16_bf16 v[16:31], v[160:163], v[168:171], v[16:31]
    v_mfma_f32_32x32x16_bf16 v[32:47], v[164:167], v[168:171], v[32:47]
    v_mfma_f32_32x32x16_bf16 v[48:63], v[160:163], v[172:175], v[48:63]
    v_mfma_f32_32x32x16_bf16 v[64:79], v[164:167], v[172:175], v[64:79]
    buffer_load_dwordx4 v[160:163], v7, s[44:47], s26 offen
    buffer_load_dwordx4 v[168:171], v7, s[44:47], s27 offen
    buffer_load_dwordx4 v[164:167], v6, s[44:47], s26 offen
    buffer_load_dwordx4 v[172:175], v6, s[44:47], s27 offen
    s_add_u32 s26, s26, 4096
    s_add_u32 s27, s27, 4096
    s_waitcnt vmcnt(24)
    v_mfma_f32_32x32x16_bf16 v[16:31], v[176:179], v[184:187], v[16:31]
    v_mfma_f32_32x32x16_bf16 v[32:47], v[180:183], v[184:187], v[32:47]
    v_mfma_f32_32x32x16_bf16 v[48:63], v[176:179], v[188:191], v[48:63]
    v_mfma_f32_32x32x16_bf16 v[64:79], v[180:183], v[188:191], v[64:79]
    buffer_load_dwordx4 v[176:179], v7, s[44:47], s26 offen
    buffer_load_dwordx4 v[184:187], v7, s[44:47], s27 offen
    buffer_load_dwordx4 v[180:183], v6, s[44:47], s26 offen
    buffer_load_dwordx4 v[188:191], v6, s[44:47], s27 offen
    s_add_u32 s26, s26, 4096
    s_add_u32 s27, s27, 4096
    s_waitcnt vmcnt(24)
    v_mfma_f32_32x32x16_bf16 v[16:31], v[80:83], v[88:91], v[16:31]
    v_mfma_f32_32x32x16_bf16 v[32:47], v[84:87], v[88:91], v[32:47]
    v_mfma_f32_32x32x16_bf16 v[48:63], v[80:83], v[92:95], v[48:63]
    v_mfma_f32_32x32x16_bf16 v[64:79], v[84:87], v[92:95], v[64:79]
    buffer_load_dwordx4 v[80:83], v7, s[44:47], s26 offen
    buffer_load_dwordx4 v[88:91], v7, s[44:47], s27 offen
    buffer_load_dwordx4 v[84:87], v6, s[44:47], s26 offen
    buffer_load_dwordx4 v[92:95], v6, s[44:47], s27 offen
    s_add_u32 s26, s26, 4096
    s_add_u32 s27, s27, 4096
    s_waitcnt vmcnt(24)
    v_mfma_f32_32x32x16_bf16 v[16:31], v[96:99], v[104:107], v[16:31]
    v_mfma_f32_32x32x16_bf16 v[32:47], v[100:103], v[104:107], v[32:47]
    v_mfma_f32_32x32x16_bf16 v[48:63], v[96:99], v[108:111], v[48:63]
    v_mfma_f32_32x32x16_bf16 v[64:79], v[100:103], v[108:111], v[64:79]
    buffer_load_dwordx4 v[96:99], v7, s[44:47], s26 offen
    buffer_load_dwordx4 v[104:107], v7, s[44:47], s27 offen
    buffer_load_dwordx4 v[100:103], v6, s[44:47], s26 offen
    buffer_load_dwordx4 v[108:111], v6, s[44:47], s27 offen
    s_add_u32 s26, s26, 4096
    s_add_u32 s27, s27, 4096
    s_waitcnt vmcnt(24)
    v_mfma_f32_32x32x16_bf16 v[16:31], v[112:115], v[120:123], v[16:31]
    v_mfma_f32_32x32x16_bf16 v[32:47], v[116:119], v[120:123], v[32:47]
    v_mfma_f32_32x32x16_bf16 v[48:63], v[112:115], v[124:127], v[48:63]
    v_mfma_f32_32x32x16_bf16 v[64:79], v[116:119], v[124:127], v[64:79]
    buffer_load_dwordx4 v[112:115], v7, s[44:47], s26 offen
    buffer_load_dwordx4 v[120:123], v7, s[44:47], s27 offen
    buffer_load_dwordx4 v[116:119], v6, s[44:47], s26 offen
    buffer_load_dwordx4 v[124:127], v6, s[44:47], s27 offen
    s_add_u32 s26, s26, 4096
    s_add_u32 s27, s27, 4096
    s_waitcnt vmcnt(24)
    v_mfma_f32_32x32x16_bf16 v[16:31], v[128:131], v[136:139], v[16:31]
    v_mfma_f32_32x32x16_bf16 v[32:47], v[132:135], v[136:139], v[32:47]
    v_mfma_f32_32x32x16_bf16 v[48:63], v[128:131], v[140:143], v[48:63]
    v_mfma_f32_32x32x16_bf16 v[64:79], v[132:135], v[140:143], v[64:79]
    buffer_load_dwordx4 v[128:131], v7, s[44:47], s26 offen
    buffer_load_dwordx4 v[136:139], v7, s[44:47], s27 offen
    buffer_load_dwordx4 v[132:135], v6, s[44:47], s26 offen
    buffer_load_dwordx4 v[140:143], v6, s[44:47], s27 offen
    s_add_u32 s26, s26, 4096
    s_add_u32 s27, s27, 4096
    s_waitcnt vmcnt(24)
    v_mfma_f32_32x32x16_bf16 v[16:31], v[144:147], v[152:155], v[16:31]
    v_mfma_f32_32x32x16_bf16 v[32:47], v[148:151], v[152:155], v[32:47]
    v_mfma_f32_32x32x16_bf16 v[48:63], v[144:147], v[156:159], v[48:63]
    v_mfma_f32_32x32x16_bf16 v[64:79], v[148:151], v[156:159], v[64:79]
    buffer_load_dwordx4 v[144:147], v7, s[44:47], s26 offen
    buffer_load_dwordx4 v[152:155], v7, s[44:47], s27 offen
    buffer_load_dwordx4 v[148:151], v6, s[44:47], s26 offen
    buffer_load_dwordx4 v[156:159], v6, s[44:47], s27 offen
    s_add_u32 s26, s26, 4096
    s_add_u32 s27, s27, 4096
    s_waitcnt vmcnt(24)
    v_mfma_f32_32x32x16_bf16 v[16:31], v[160:163], v[168:171], v[16:31]
    v_mfma_f32_32x32x16_bf16 v[32:47], v[164:167], v[168:171], v[32:47]
    v_mfma_f32_32x32x16_bf16 v[48:63], v[160:163], v[172:175], v[48:63]
    v_mfma_f32_32x32x16_bf16 v[64:79], v[164:167], v[172:175], v[64:79]
    buffer_load_dwordx4 v[160:163], v7, s[44:47], s26 offen
    buffer_load_dwordx4 v[168:171], v7, s[44:47], s27 offen
    buffer_load_dwordx4 v[164:167], v6, s[44:47], s26 offen
    buffer_load_dwordx4 v[172:175], v6, s[44:47], s27 offen
    s_add_u32 s26, s26, 4096
    s_add_u32 s27, s27, 4096
    s_waitcnt vmcnt(24)
    v_mfma_f32_32x32x16_bf16 v[16:31], v[176:179], v[184:187], v[16:31]
    v_mfma_f32_32x32x16_bf16 v[32:47], v[180:183], v[184:187], v[32:47]
    v_mfma_f32_32x32x16_bf16 v[48:63], v[176:179], v[188:191], v[48:63]
    v_mfma_f32_32x32x16_bf16 v[64:79], v[180:183], v[188:191], v[64:79]
    buffer_load_dwordx4 v[176:179], v7, s[44:47], s26 offen
    buffer_load_dwordx4 v[184:187], v7, s[44:47], s27 offen
    buffer_load_dwordx4 v[180:183], v6, s[44:47], s26 offen
    buffer_load_dwordx4 v[188:191], v6, s[44:47], s27 offen
    s_add_u32 s26, s26, 4096
    s_add_u32 s27, s27, 4096
    s_waitcnt vmcnt(24)
    v_mfma_f32_32x32x16_bf16 v[16:31], v[80:83], v[88:91], v[16:31]
    v_mfma_f32_32x32x16_bf16 v[32:47], v[84:87], v[88:91], v[32:47]
    v_mfma_f32_32x32x16_bf16 v[48:63], v[80:83], v[92:95], v[48:63]
    v_mfma_f32_32x32x16_bf16 v[64:79], v[84:87], v[92:95], v[64:79]
    buffer_load_dwordx4 v[80:83], v7, s[44:47], s26 offen
    buffer_load_dwordx4 v[88:91], v7, s[44:47], s27 offen
    buffer_load_dwordx4 v[84:87], v6, s[44:47], s26 offen
    buffer_load_dwordx4 v[92:95], v6, s[44:47], s27 offen
    s_add_u32 s26, s26, 4096
    s_add_u32 s27, s27, 4096
    s_waitcnt vmcnt(24)
    v_mfma_f32_32x32x16_bf16 v[16:31], v[96:99], v[104:107], v[16:31]
    v_mfma_f32_32x32x16_bf16 v[32:47], v[100:103], v[104:107], v[32:47]
    v_mfma_f32_32x32x16_bf16 v[48:63], v[96:99], v[108:111], v[48:63]
    v_mfma_f32_32x32x16_bf16 v[64:79], v[100:103], v[108:111], v[64:79]
    buffer_load_dwordx4 v[96:99], v7, s[44:47], s26 offen
    buffer_load_dwordx4 v[104:107], v7, s[44:47], s27 offen
    buffer_load_dwordx4 v[100:103], v6, s[44:47], s26 offen
    buffer_load_dwordx4 v[108:111], v6, s[44:47], s27 offen
    s_add_u32 s26, s26, 4096
    s_add_u32 s27, s27, 4096
    s_waitcnt vmcnt(24)
    v_mfma_f32_32x32x16_bf16 v[16:31], v[112:115], v[120:123], v[16:31]
    v_mfma_f32_32x32x16_bf16 v[32:47], v[116:119], v[120:123], v[32:47]
    v_mfma_f32_32x32x16_bf16 v[48:63], v[112:115], v[124:127], v[48:63]
    v_mfma_f32_32x32x16_bf16 v[64:79], v[116:119], v[124:127], v[64:79]
    buffer_load_dwordx4 v[112:115], v7, s[44:47], s26 offen
    buffer_load_dwordx4 v[120:123], v7, s[44:47], s27 offen
    buffer_load_dwordx4 v[116:119], v6, s[44:47], s26 offen
    buffer_load_dwordx4 v[124:127], v6, s[44:47], s27 offen
    s_add_u32 s26, s26, 4096
    s_add_u32 s27, s27, 4096
    s_waitcnt vmcnt(24)
    v_mfma_f32_32x32x16_bf16 v[16:31], v[128:131], v[136:139], v[16:31]
    v_mfma_f32_32x32x16_bf16 v[32:47], v[132:135], v[136:139], v[32:47]
    v_mfma_f32_32x32x16_bf16 v[48:63], v[128:131], v[140:143], v[48:63]
    v_mfma_f32_32x32x16_bf16 v[64:79], v[132:135], v[140:143], v[64:79]
    buffer_load_dwordx4 v[128:131], v7, s[44:47], s26 offen
    buffer_load_dwordx4 v[136:139], v7, s[44:47], s27 offen
    buffer_load_dwordx4 v[132:135], v6, s[44:47], s26 offen
    buffer_load_dwordx4 v[140:143], v6, s[44:47], s27 offen
    s_add_u32 s26, s26, 4096
    s_add_u32 s27, s27, 4096
    s_waitcnt vmcnt(24)
    v_mfma_f32_32x32x16_bf16 v[16:31], v[144:147], v[152:155], v[16:31]
    v_mfma_f32_32x32x16_bf16 v[32:47], v[148:151], v[152:155], v[32:47]
    v_mfma_f32_32x32x16_bf16 v[48:63], v[144:147], v[156:159], v[48:63]
    v_mfma_f32_32x32x16_bf16 v[64:79], v[148:151], v[156:159], v[64:79]
    buffer_load_dwordx4 v[144:147], v7, s[44:47], s26 offen
    buffer_load_dwordx4 v[152:155], v7, s[44:47], s27 offen
    buffer_load_dwordx4 v[148:151], v6, s[44:47], s26 offen
    buffer_load_dwordx4 v[156:159], v6, s[44:47], s27 offen
    s_add_u32 s26, s26, 4096
    s_add_u32 s27, s27, 4096
    s_waitcnt vmcnt(24)
    v_mfma_f32_32x32x16_bf16 v[16:31], v[160:163], v[168:171], v[16:31]
    v_mfma_f32_32x32x16_bf16 v[32:47], v[164:167], v[168:171], v[32:47]
    v_mfma_f32_32x32x16_bf16 v[48:63], v[160:163], v[172:175], v[48:63]
    v_mfma_f32_32x32x16_bf16 v[64:79], v[164:167], v[172:175], v[64:79]
    buffer_load_dwordx4 v[160:163], v7, s[44:47], s26 offen
    buffer_load_dwordx4 v[168:171], v7, s[44:47], s27 offen
    buffer_load_dwordx4 v[164:167], v6, s[44:47], s26 offen
    buffer_load_dwordx4 v[172:175], v6, s[44:47], s27 offen
    s_add_u32 s26, s26, 4096
    s_add_u32 s27, s27, 4096
    s_waitcnt vmcnt(24)
    v_mfma_f32_32x32x16_bf16 v[16:31], v[176:179], v[184:187], v[16:31]
    v_mfma_f32_32x32x16_bf16 v[32:47], v[180:183], v[184:187], v[32:47]
    v_mfma_f32_32x32x16_bf16 v[48:63], v[176:179], v[188:191], v[48:63]
    v_mfma_f32_32x32x16_bf16 v[64:79], v[180:183], v[188:191], v[64:79]
    buffer_load_dwordx4 v[176:179], v7, s[44:47], s26 offen
    buffer_load_dwordx4 v[184:187], v7, s[44:47], s27 offen
    buffer_load_dwordx4 v[180:183], v6, s[44:47], s26 offen
    buffer_load_dwordx4 v[188:191], v6, s[44:47], s27 offen
    s_add_u32 s26, s26, 4096
    s_add_u32 s27, s27, 4096
    s_waitcnt vmcnt(24)
    v_mfma_f32_32x32x16_bf16 v[16:31], v[80:83], v[88:91], v[16:31]
    v_mfma_f32_32x32x16_bf16 v[32:47], v[84:87], v[88:91], v[32:47]
    v_mfma_f32_32x32x16_bf16 v[48:63], v[80:83], v[92:95], v[48:63]
    v_mfma_f32_32x32x16_bf16 v[64:79], v[84:87], v[92:95], v[64:79]
    buffer_load_dwordx4 v[80:83], v7, s[44:47], s26 offen
    buffer_load_dwordx4 v[88:91], v7, s[44:47], s27 offen
    buffer_load_dwordx4 v[84:87], v6, s[44:47], s26 offen
    buffer_load_dwordx4 v[92:95], v6, s[44:47], s27 offen
    s_add_u32 s26, s26, 4096
    s_add_u32 s27, s27, 4096
    s_waitcnt vmcnt(24)
    v_mfma_f32_32x32x16_bf16 v[16:31], v[96:99], v[104:107], v[16:31]
    v_mfma_f32_32x32x16_bf16 v[32:47], v[100:103], v[104:107], v[32:47]
    v_mfma_f32_32x32x16_bf16 v[48:63], v[96:99], v[108:111], v[48:63]
    v_mfma_f32_32x32x16_bf16 v[64:79], v[100:103], v[108:111], v[64:79]
    buffer_load_dwordx4 v[96:99], v7, s[44:47], s26 offen
    buffer_load_dwordx4 v[104:107], v7, s[44:47], s27 offen
    buffer_load_dwordx4 v[100:103], v6, s[44:47], s26 offen
    buffer_load_dwordx4 v[108:111], v6, s[44:47], s27 offen
    s_add_u32 s26, s26, 4096
    s_add_u32 s27, s27, 4096
    s_waitcnt vmcnt(24)
    v_mfma_f32_32x32x16_bf16 v[16:31], v[112:115], v[120:123], v[16:31]
    v_mfma_f32_32x32x16_bf16 v[32:47], v[116:119], v[120:123], v[32:47]
    v_mfma_f32_32x32x16_bf16 v[48:63], v[112:115], v[124:127], v[48:63]
    v_mfma_f32_32x32x16_bf16 v[64:79], v[116:119], v[124:127], v[64:79]
    buffer_load_dwordx2 v[8:9], v2, s[28:31], s36 offen offset:0
    buffer_load_dwordx2 v[10:11], v2, s[28:31], s36 offen offset:16
    buffer_load_dwordx2 v[12:13], v2, s[28:31], s36 offen offset:32
    buffer_load_dwordx2 v[14:15], v2, s[28:31], s36 offen offset:48
    s_waitcnt vmcnt(24)
    v_mfma_f32_32x32x16_bf16 v[16:31], v[128:131], v[136:139], v[16:31]
    v_mfma_f32_32x32x16_bf16 v[32:47], v[132:135], v[136:139], v[32:47]
    v_mfma_f32_32x32x16_bf16 v[48:63], v[128:131], v[140:143], v[48:63]
    v_mfma_f32_32x32x16_bf16 v[64:79], v[132:135], v[140:143], v[64:79]
    s_waitcnt vmcnt(20)
    v_mfma_f32_32x32x16_bf16 v[16:31], v[144:147], v[152:155], v[16:31]
    v_mfma_f32_32x32x16_bf16 v[32:47], v[148:151], v[152:155], v[32:47]
    v_mfma_f32_32x32x16_bf16 v[48:63], v[144:147], v[156:159], v[48:63]
    v_mfma_f32_32x32x16_bf16 v[64:79], v[148:151], v[156:159], v[64:79]
    s_waitcnt vmcnt(16)
    v_mfma_f32_32x32x16_bf16 v[16:31], v[160:163], v[168:171], v[16:31]
    v_mfma_f32_32x32x16_bf16 v[32:47], v[164:167], v[168:171], v[32:47]
    v_mfma_f32_32x32x16_bf16 v[48:63], v[160:163], v[172:175], v[48:63]
    v_mfma_f32_32x32x16_bf16 v[64:79], v[164:167], v[172:175], v[64:79]
    s_waitcnt vmcnt(12)
    v_mfma_f32_32x32x16_bf16 v[16:31], v[176:179], v[184:187], v[16:31]
    v_mfma_f32_32x32x16_bf16 v[32:47], v[180:183], v[184:187], v[32:47]
    v_mfma_f32_32x32x16_bf16 v[48:63], v[176:179], v[188:191], v[48:63]
    v_mfma_f32_32x32x16_bf16 v[64:79], v[180:183], v[188:191], v[64:79]
    s_waitcnt vmcnt(8)
    v_mfma_f32_32x32x16_bf16 v[16:31], v[80:83], v[88:91], v[16:31]
    v_mfma_f32_32x32x16_bf16 v[32:47], v[84:87], v[88:91], v[32:47]
    v_mfma_f32_32x32x16_bf16 v[48:63], v[80:83], v[92:95], v[48:63]
    v_mfma_f32_32x32x16_bf16 v[64:79], v[84:87], v[92:95], v[64:79]
    s_waitcnt vmcnt(4)
    s_cmp_ge_u32 s3, 2
    s_cbranch_scc1 k3_red
    v_mfma_f32_32x32x16_bf16 v[16:31], v[96:99], v[104:107], v[16:31]
    v_mfma_f32_32x32x16_bf16 v[32:47], v[100:103], v[104:107], v[32:47]
    v_mfma_f32_32x32x16_bf16 v[48:63], v[96:99], v[108:111], v[48:63]
    v_mfma_f32_32x32x16_bf16 v[64:79], v[100:103], v[108:111], v[64:79]
k3_red:
    s_lshl_b32 s39, s3, 12
    v_add_u32 v4, s39, v7
    s_nop 15
    s_cmp_eq_u32 s3, 0
    s_cbranch_scc1 k3_sk0
    ds_write_b128 v4, v[16:19] offset:0
    ds_write_b128 v4, v[20:23] offset:1024
    ds_write_b128 v4, v[24:27] offset:2048
    ds_write_b128 v4, v[28:31] offset:3072
    s_branch k3_n0
k3_sk0:
    v_mov_b32 v144, v16
    v_mov_b32 v145, v17
    v_mov_b32 v146, v18
    v_mov_b32 v147, v19
    v_mov_b32 v148, v20
    v_mov_b32 v149, v21
    v_mov_b32 v150, v22
    v_mov_b32 v151, v23
    v_mov_b32 v152, v24
    v_mov_b32 v153, v25
    v_mov_b32 v154, v26
    v_mov_b32 v155, v27
    v_mov_b32 v156, v28
    v_mov_b32 v157, v29
    v_mov_b32 v158, v30
    v_mov_b32 v159, v31
k3_n0:
    s_cmp_eq_u32 s3, 1
    s_cbranch_scc1 k3_sk1
    ds_write_b128 v4, v[32:35] offset:16384
    ds_write_b128 v4, v[36:39] offset:17408
    ds_write_b128 v4, v[40:43] offset:18432
    ds_write_b128 v4, v[44:47] offset:19456
    s_branch k3_n1
k3_sk1:
    v_mov_b32 v144, v32
    v_mov_b32 v145, v33
    v_mov_b32 v146, v34
    v_mov_b32 v147, v35
    v_mov_b32 v148, v36
    v_mov_b32 v149, v37
    v_mov_b32 v150, v38
    v_mov_b32 v151, v39
    v_mov_b32 v152, v40
    v_mov_b32 v153, v41
    v_mov_b32 v154, v42
    v_mov_b32 v155, v43
    v_mov_b32 v156, v44
    v_mov_b32 v157, v45
    v_mov_b32 v158, v46
    v_mov_b32 v159, v47
k3_n1:
    s_cmp_eq_u32 s3, 2
    s_cbranch_scc1 k3_sk2
    ds_write_b128 v4, v[48:51] offset:32768
    ds_write_b128 v4, v[52:55] offset:33792
    ds_write_b128 v4, v[56:59] offset:34816
    ds_write_b128 v4, v[60:63] offset:35840
    s_branch k3_n2
k3_sk2:
    v_mov_b32 v144, v48
    v_mov_b32 v145, v49
    v_mov_b32 v146, v50
    v_mov_b32 v147, v51
    v_mov_b32 v148, v52
    v_mov_b32 v149, v53
    v_mov_b32 v150, v54
    v_mov_b32 v151, v55
    v_mov_b32 v152, v56
    v_mov_b32 v153, v57
    v_mov_b32 v154, v58
    v_mov_b32 v155, v59
    v_mov_b32 v156, v60
    v_mov_b32 v157, v61
    v_mov_b32 v158, v62
    v_mov_b32 v159, v63
k3_n2:
    s_cmp_eq_u32 s3, 3
    s_cbranch_scc1 k3_sk3
    ds_write_b128 v4, v[64:67] offset:49152
    ds_write_b128 v4, v[68:71] offset:50176
    ds_write_b128 v4, v[72:75] offset:51200
    ds_write_b128 v4, v[76:79] offset:52224
    s_branch k3_n3
k3_sk3:
    v_mov_b32 v144, v64
    v_mov_b32 v145, v65
    v_mov_b32 v146, v66
    v_mov_b32 v147, v67
    v_mov_b32 v148, v68
    v_mov_b32 v149, v69
    v_mov_b32 v150, v70
    v_mov_b32 v151, v71
    v_mov_b32 v152, v72
    v_mov_b32 v153, v73
    v_mov_b32 v154, v74
    v_mov_b32 v155, v75
    v_mov_b32 v156, v76
    v_mov_b32 v157, v77
    v_mov_b32 v158, v78
    v_mov_b32 v159, v79
k3_n3:
    s_waitcnt lgkmcnt(0)
    s_barrier
    s_lshl_b32 s39, s3, 14
    s_add_u32 s40, s3, 1
    s_and_b32 s40, s40, 3
    s_lshl_b32 s40, s40, 12
    s_add_u32 s40, s40, s39
    v_add_u32 v5, s40, v7
    ds_read_b128 v[80:83], v5 offset:0
    ds_read_b128 v[84:87], v5 offset:1024
    ds_read_b128 v[88:91], v5 offset:2048
    ds_read_b128 v[92:95], v5 offset:3072
    s_add_u32 s40, s3, 2
    s_and_b32 s40, s40, 3
    s_lshl_b32 s40, s40, 12
    s_add_u32 s40, s40, s39
    v_add_u32 v5, s40, v7
    ds_read_b128 v[96:99], v5 offset:0
    ds_read_b128 v[100:103], v5 offset:1024
    ds_read_b128 v[104:107], v5 offset:2048
    ds_read_b128 v[108:111], v5 offset:3072
    s_add_u32 s40, s3, 3
    s_and_b32 s40, s40, 3
    s_lshl_b32 s40, s40, 12
    s_add_u32 s40, s40, s39
    v_add_u32 v5, s40, v7
    ds_read_b128 v[112:115], v5 offset:0
    ds_read_b128 v[116:119], v5 offset:1024
    ds_read_b128 v[120:123], v5 offset:2048
    ds_read_b128 v[124:127], v5 offset:3072
    s_waitcnt vmcnt(0)
    v_lshlrev_b32 v1, 16, v8
    v_add_f32 v144, v144, v1
    v_and_b32 v1, 0xffff0000, v8
    v_add_f32 v145, v145, v1
    v_lshlrev_b32 v1, 16, v9
    v_add_f32 v146, v146, v1
    v_and_b32 v1, 0xffff0000, v9
    v_add_f32 v147, v147, v1
    v_lshlrev_b32 v1, 16, v10
    v_add_f32 v148, v148, v1
    v_and_b32 v1, 0xffff0000, v10
    v_add_f32 v149, v149, v1
    v_lshlrev_b32 v1, 16, v11
    v_add_f32 v150, v150, v1
    v_and_b32 v1, 0xffff0000, v11
    v_add_f32 v151, v151, v1
    v_lshlrev_b32 v1, 16, v12
    v_add_f32 v152, v152, v1
    v_and_b32 v1, 0xffff0000, v12
    v_add_f32 v153, v153, v1
    v_lshlrev_b32 v1, 16, v13
    v_add_f32 v154, v154, v1
    v_and_b32 v1, 0xffff0000, v13
    v_add_f32 v155, v155, v1
    v_lshlrev_b32 v1, 16, v14
    v_add_f32 v156, v156, v1
    v_and_b32 v1, 0xffff0000, v14
    v_add_f32 v157, v157, v1
    v_lshlrev_b32 v1, 16, v15
    v_add_f32 v158, v158, v1
    v_and_b32 v1, 0xffff0000, v15
    v_add_f32 v159, v159, v1
    s_waitcnt lgkmcnt(8)
    v_add_f32 v144, v144, v80
    v_add_f32 v145, v145, v81
    v_add_f32 v146, v146, v82
    v_add_f32 v147, v147, v83
    v_add_f32 v148, v148, v84
    v_add_f32 v149, v149, v85
    v_add_f32 v150, v150, v86
    v_add_f32 v151, v151, v87
    v_add_f32 v152, v152, v88
    v_add_f32 v153, v153, v89
    v_add_f32 v154, v154, v90
    v_add_f32 v155, v155, v91
    v_add_f32 v156, v156, v92
    v_add_f32 v157, v157, v93
    v_add_f32 v158, v158, v94
    v_add_f32 v159, v159, v95
    s_waitcnt lgkmcnt(4)
    v_add_f32 v144, v144, v96
    v_add_f32 v145, v145, v97
    v_add_f32 v146, v146, v98
    v_add_f32 v147, v147, v99
    v_add_f32 v148, v148, v100
    v_add_f32 v149, v149, v101
    v_add_f32 v150, v150, v102
    v_add_f32 v151, v151, v103
    v_add_f32 v152, v152, v104
    v_add_f32 v153, v153, v105
    v_add_f32 v154, v154, v106
    v_add_f32 v155, v155, v107
    v_add_f32 v156, v156, v108
    v_add_f32 v157, v157, v109
    v_add_f32 v158, v158, v110
    v_add_f32 v159, v159, v111
    s_waitcnt lgkmcnt(0)
    v_add_f32 v144, v144, v112
    v_add_f32 v145, v145, v113
    v_add_f32 v146, v146, v114
    v_add_f32 v147, v147, v115
    v_add_f32 v148, v148, v116
    v_add_f32 v149, v149, v117
    v_add_f32 v150, v150, v118
    v_add_f32 v151, v151, v119
    v_add_f32 v152, v152, v120
    v_add_f32 v153, v153, v121
    v_add_f32 v154, v154, v122
    v_add_f32 v155, v155, v123
    v_add_f32 v156, v156, v124
    v_add_f32 v157, v157, v125
    v_add_f32 v158, v158, v126
    v_add_f32 v159, v159, v127
    v_cvt_pk_bf16_f32 v8, v144, v145
    v_cvt_pk_bf16_f32 v9, v146, v147
    v_cvt_pk_bf16_f32 v10, v148, v149
    v_cvt_pk_bf16_f32 v11, v150, v151
    v_cvt_pk_bf16_f32 v12, v152, v153
    v_cvt_pk_bf16_f32 v13, v154, v155
    v_cvt_pk_bf16_f32 v14, v156, v157
    v_cvt_pk_bf16_f32 v15, v158, v159
    s_lshr_b32 s41, s3, 1
    s_mul_i32 s41, s41, 20480
    s_lshl_b32 s42, s38, 6
    v_and_b32 v16, 31, v0
    v_and_b32 v17, 7, v0
    v_lshlrev_b32 v18, 4, v17
    v_xor_b32 v18, s42, v18
    v_lshl_add_u32 v18, v16, 7, v18
    v_lshl_add_u32 v18, v3, 3, v18
    v_add_u32 v18, s41, v18
    v_xor_b32 v20, 0, v18
    ds_write_b64 v20, v[8:9]
    v_xor_b32 v21, 16, v18
    ds_write_b64 v21, v[10:11]
    v_xor_b32 v22, 32, v18
    ds_write_b64 v22, v[12:13]
    v_xor_b32 v23, 48, v18
    ds_write_b64 v23, v[14:15]
    v_lshrrev_b32 v16, 3, v0
    v_xor_b32 v19, v17, v16
    v_lshlrev_b32 v19, 4, v19
    v_lshl_add_u32 v19, v16, 7, v19
    s_lshl_b32 s42, s38, 11
    s_add_u32 s41, s41, s42
    v_add_u32 v19, s41, v19
    v_lshlrev_b32 v16, 10, v16
    v_lshl_add_u32 v16, v17, 4, v16
    s_lshl_b32 s41, s24, 2
    s_add_u32 s41, s41, s3
    s_lshl_b32 s41, s41, 14
    s_lshl_b32 s42, s25, 7
    s_add_u32 s41, s41, s42
    s_add_u32 s42, s41, 8192
    s_waitcnt lgkmcnt(0)
    s_barrier
    ds_read_b128 v[24:27], v19
    ds_read_b128 v[28:31], v19 offset:1024
    s_waitcnt lgkmcnt(1)
    buffer_store_dwordx4 v[24:27], v16, s[32:35], s41 offen sc0 sc1
    s_waitcnt lgkmcnt(0)
    buffer_store_dwordx4 v[28:31], v16, s[32:35], s42 offen sc0 sc1
    s_waitcnt vmcnt(0)
k3_end:
    s_endpgm
.section .rodata,"a"
.p2align 6
.amdhsa_kernel prep_kernel
  .amdhsa_next_free_vgpr 96
  .amdhsa_next_free_sgpr 102
  .amdhsa_accum_offset 96
  .amdhsa_group_segment_fixed_size 0
  .amdhsa_kernarg_size 96
  .amdhsa_user_sgpr_count 2
  .amdhsa_user_sgpr_kernarg_segment_ptr 1
  .amdhsa_system_sgpr_workgroup_id_x 1
.end_amdhsa_kernel
.p2align 6
.amdhsa_kernel attn_kernel
  .amdhsa_next_free_vgpr 136
  .amdhsa_next_free_sgpr 102
  .amdhsa_accum_offset 136
  .amdhsa_group_segment_fixed_size 0
  .amdhsa_kernarg_size 96
  .amdhsa_user_sgpr_count 2
  .amdhsa_user_sgpr_kernarg_segment_ptr 1
  .amdhsa_system_sgpr_workgroup_id_x 1
.end_amdhsa_kernel
.p2align 6
.amdhsa_kernel outp_kernel
  .amdhsa_next_free_vgpr 192
  .amdhsa_next_free_sgpr 102
  .amdhsa_accum_offset 192
  .amdhsa_group_segment_fixed_size 0
  .amdhsa_kernarg_size 96
  .amdhsa_user_sgpr_count 2
  .amdhsa_user_sgpr_kernarg_segment_ptr 1
  .amdhsa_system_sgpr_workgroup_id_x 1
.end_amdhsa_kernel
```
